```python
import torch

def _softmax(x, axis=-1):
    return torch.softmax(x, dim=axis)
def _gelu(x):
    return torch.nn.functional.gelu(x, approximate="tanh")
def _silu(x):
    return torch.nn.functional.silu(x)
def _sigmoid(x):
    return torch.sigmoid(x)
def _layernorm(x, axis=-1, eps=1e-5):
    m = x.mean(dim=axis, keepdim=True)
    v = x.var(dim=axis, keepdim=True, unbiased=False)
    return (x - m) / torch.sqrt(v + eps)
def _scatter_add(tgt, idx, src, axis=0):
    return tgt.clone().index_add_(axis, idx, src)
def _segment_sum(src, seg, n):
    out = torch.zeros((n,) + src.shape[1:], dtype=src.dtype)
    return out.index_add_(0, seg, src)
def _pad(x, pw):
    flat = tuple(v for pair in reversed(pw) for v in pair)
    return torch.nn.functional.pad(x, flat)

kernel_name = 'parallel_sum__ssm_conv_s4__glu_gated_bilinear__prompt'

def setup_inputs():

    _w = (lambda a: (lambda t: t.to(torch.bfloat16) if t.is_floating_point() else t)(torch.as_tensor(a)))
    def _A_setup():
        B, L, D, N = 1, 2048, 512, 128
        A_re = -(lambda _x: torch.exp(torch.as_tensor(_x)))((lambda *s: torch.randn(*s, dtype=torch.bfloat16) * 6.4)(D, N))
        A_im = torch.pi * (lambda *s: torch.randn(*s, dtype=torch.bfloat16) * 0.05)(D, N)
        B_re = (lambda *s: torch.randn(*s, dtype=torch.bfloat16) * 0.1)(D, N)
        B_im = (lambda *s: torch.randn(*s, dtype=torch.bfloat16) * 0.1)(D, N)
        C_re = (lambda *s: torch.randn(*s, dtype=torch.bfloat16) * 0.1)(D, N)
        C_im = (lambda *s: torch.randn(*s, dtype=torch.bfloat16) * 0.1)(D, N)
        log_dt = (lambda *s: torch.randn(*s, dtype=torch.bfloat16) * 0.05)(D) * 0.5 - 4.0
        Dskip = (lambda *s: torch.randn(*s, dtype=torch.bfloat16) * 0.05)(D)
        return {
            "u": _w((lambda *s: torch.randn(*s, dtype=torch.bfloat16) * 0.05)(B, L, D)),
            "A_re": _w(A_re),
            "A_im": _w(A_im),
            "B_re": _w(B_re),
            "B_im": _w(B_im),
            "C_re": _w(C_re),
            "C_im": _w(C_im),
            "log_dt": _w(log_dt),
            "Dskip": _w(Dskip),
        }
    _A_in = _A_setup()

    def _B_setup():
        B, S, D, F = 1, 2048, 512, 1376
        return {
            "x": _w((lambda *s: torch.randn(*s, dtype=torch.bfloat16) * 0.05)(B, S, D)),
            "w_gate": _w((lambda *s: torch.randn(*s, dtype=torch.bfloat16) * 0.4)(D, F) * (D ** -0.5)),
            "w_up": _w((lambda *s: torch.randn(*s, dtype=torch.bfloat16) * 0.4)(D, F) * (D ** -0.5)),
            "w_down": _w((lambda *s: torch.randn(*s, dtype=torch.bfloat16) * 0.4)(F, D) * (F ** -0.5)),
        }
    _B_in = _B_setup()

    return {
        "A_u": _A_in["u"],
        "A_A_re": _A_in["A_re"],
        "A_A_im": _A_in["A_im"],
        "A_B_re": _A_in["B_re"],
        "A_B_im": _A_in["B_im"],
        "A_C_re": _A_in["C_re"],
        "A_C_im": _A_in["C_im"],
        "A_log_dt": _A_in["log_dt"],
        "A_Dskip": _A_in["Dskip"],
        "B_x": _B_in["x"],
        "B_w_gate": _B_in["w_gate"],
        "B_w_up": _B_in["w_up"],
        "B_w_down": _B_in["w_down"],
    }

def reference(A_u, A_A_re, A_A_im, A_B_re, A_B_im, A_C_re, A_C_im, A_log_dt, A_Dskip, B_x, B_w_gate, B_w_up, B_w_down):
    def _A_ref(u, A_re, A_im, B_re, B_im, C_re, C_im, log_dt, Dskip):
        Bsz, L, D = u.shape
        dt = torch.exp(log_dt)[:, None]
        A = A_re + 1j * A_im
        Bc = B_re + 1j * B_im
        Cc = C_re + 1j * C_im
        logdA = dt * A
        dB = dt * Bc
        l = (lambda x, dt: x.to(dt))(torch.arange(L), A_re.dtype)
        P = torch.exp(logdA[:, :, None] * l[None, None, :])
        K = torch.einsum("dn,dnl,dn->dl", Cc, P, dB).real
        L2 = 2 * L
        Kp = _pad(K, ((0, 0), (0, L)))
        up = (lambda x, *d: x.permute(*d))(u, 0, 2, 1)
        up = _pad(up, ((0, 0), (0, 0), (0, L)))
        Kf = (lambda x, axes=(-2,-1): torch.fft.rfft2(x.float(), dim=axes))(Kp[:, None, :], axes=(-2, -1))
        Uf = (lambda x, axes=(-2,-1): torch.fft.rfft2(x.float(), dim=axes))(up[:, :, None, :], axes=(-2, -1))
        Yf = Uf * Kf[None, :, :, :]
        y = (lambda x, s, axes=(-2,-1): torch.fft.irfft2(x, s=s, dim=axes).to(torch.bfloat16))(Yf, (1, L2), axes=(-2, -1))[:, :, 0, :L]
        y = (lambda x, *d: x.permute(*d))(y, 0, 2, 1) + u * Dskip[None, None, :]
        return y

    def _B_ref(x, w_gate, w_up, w_down):
        g = torch.einsum("bsd,df->bsf", x, w_gate)
        u = torch.einsum("bsd,df->bsf", x, w_up)
        h = g * u
        return torch.einsum("bsf,fd->bsd", h, w_down)

    x = A_u
    xn = _layernorm(x, axis=-1)
    return x + _A_ref(xn, A_A_re, A_A_im, A_B_re, A_B_im, A_C_re, A_C_im, A_log_dt, A_Dskip) + _B_ref(xn, B_w_gate, B_w_up, B_w_down)
```

```asm
; @launch grid=(256,1,1) block=(256,1,1) lds=163840
.amdgcn_target "amdgcn-amd-amdhsa--gfx950"
.text
.globl parallel_sum__ssm_conv_s4__glu_gated_bilinear__prompt_kernel
.p2align 8
.type parallel_sum__ssm_conv_s4__glu_gated_bilinear__prompt_kernel,@function
parallel_sum__ssm_conv_s4__glu_gated_bilinear__prompt_kernel:
    s_cmp_ge_u32 s2, 0x100
    s_cbranch_scc1 END_1
    s_load_dwordx16 s[4:19], s[0:1], 0
    s_load_dwordx2 s[20:21], s[0:1], 64
    s_getpc_b64 s[22:23]
PC_2:
    s_lshl_b32 s3, s2, 2
    v_lshrrev_b32 v2, 3, v0
    s_and_b32 s3, s3, 0xe0
    v_mov_b32 v5, s23
    v_add_lshl_u32 v2, v2, s3, 7
    v_min_u32 v2, END_1-PC_2, v2
    v_add_co_u32 v4, vcc, s22, v2
    v_addc_co_u32 v5, vcc, 0, v5, vcc
    global_load_dword v196, v[4:5], off
    s_load_dwordx2 s[36:37], s[0:1], 0
    s_load_dwordx2 s[40:41], s[0:1], 80
    s_load_dwordx2 s[44:45], s[0:1], 88
    s_load_dwordx2 s[48:49], s[0:1], 96
    s_load_dwordx2 s[56:57], s[0:1], 104
    s_load_dwordx2 s[60:61], s[0:1], 112
    s_load_dwordx2 s[52:53], s[0:1], 120
    s_mov_b32 s38, 0x200000
    s_mov_b32 s39, 0x00020000
    s_mov_b32 s42, 0x158000
    s_mov_b32 s43, 0x00020000
    s_mov_b32 s46, 0x158000
    s_mov_b32 s47, 0x00020000
    s_mov_b32 s50, 0x158000
    s_mov_b32 s51, 0x00020000
    s_mov_b32 s58, 0x200000
    s_mov_b32 s59, 0x00020000
    s_mov_b32 s62, 0x100
    s_mov_b32 s63, 0x00020000
    s_mov_b32 s54, 0xc02b00
    s_mov_b32 s55, 0x00020000
    v_lshrrev_b32 v2, 6, v0
    v_and_b32 v1, 63, v0
    v_readfirstlane_b32 s66, v2
    s_and_b32 s64, s2, 7
    s_lshr_b32 s65, s2, 3
    s_lshl_b32 s67, s64, 5
    s_add_u32 s67, s67, s65
    s_and_b32 s26, s64, 1
    s_lshr_b32 s27, s64, 1
    s_lshl_b32 s70, s26, 7
    s_lshl_b32 s28, s27, 5
    s_add_u32 s70, s70, s28
    s_add_u32 s70, s70, s65
    s_mul_i32 s28, s27, 30
    s_add_u32 s28, s28, s65
    s_lshr_b32 s68, s28, 3
    s_and_b32 s28, s28, 7
    s_lshl_b32 s69, s26, 3
    s_add_u32 s69, s69, s28
    s_lshl_b32 s27, s27, 2
    s_lshl_b32 s26, s26, 1
    s_add_u32 s27, s27, s26
    s_add_u32 s27, s27, s65
    s_sub_u32 s27, s27, 30
    s_cmp_ge_u32 s65, 30
    s_cselect_b32 s68, s27, s68
    s_mov_b32 s85, 0xffff0000
    s_lshl_b32 s26, s70, 13
    s_lshl_b32 s27, s66, 11
    s_add_u32 s26, s26, s27
    v_lshl_add_u32 v3, v1, 4, s26
    s_lshl_b32 s26, s67, 9
    v_lshl_add_u32 v198, v0, 1, s26
    v_mov_b32 v184, 0
    v_mov_b32 v185, 0
    v_mov_b32 v186, 0
    v_mov_b32 v187, 0
    v_mov_b32 v188, 0
    v_mov_b32 v189, 0
    s_lshl_b32 s26, s69, 17
    s_lshl_b32 s27, s66, 15
    s_add_u32 s26, s26, s27
    s_cmp_ge_u32 s65, 30
    s_cselect_b32 s26, 0x80000000, s26
    v_lshrrev_b32 v5, 3, v1
    v_lshl_add_u32 v5, v5, 10, s26
    v_lshrrev_b32 v6, 4, v1
    v_xor_b32 v7, v1, v6
    v_and_b32 v7, 7, v7
    v_lshl_add_u32 v200, v7, 4, v5
    v_xor_b32 v5, 64, v200
    v_add_u32 v201, 7168, v5
    v_add_u32 v202, 14336, v200
    v_add_u32 v203, 21504, v5
    s_mul_i32 s26, s68, 192
    s_mul_i32 s27, s66, 44032
    v_add_u32 v5, 0, v1
    v_mul_u32_u24 v7, 5462, v5
    v_lshrrev_b32 v7, 16, v7
    v_mul_u32_u24 v8, 12, v7
    v_sub_u32 v8, v5, v8
    v_lshl_add_u32 v8, v8, 4, s26
    v_min_u32 v8, 2736, v8
    v_mul_u32_u24 v7, 2752, v7
    v_add3_u32 v204, v7, v8, s27
    v_add_u32 v5, 64, v1
    v_mul_u32_u24 v7, 5462, v5
    v_lshrrev_b32 v7, 16, v7
    v_mul_u32_u24 v8, 12, v7
    v_sub_u32 v8, v5, v8
    v_lshl_add_u32 v8, v8, 4, s26
    v_min_u32 v8, 2736, v8
    v_mul_u32_u24 v7, 2752, v7
    v_add3_u32 v205, v7, v8, s27
    v_subrev_u32 v205, 1024, v205
    v_add_u32 v5, 128, v1
    v_mul_u32_u24 v7, 5462, v5
    v_lshrrev_b32 v7, 16, v7
    v_mul_u32_u24 v8, 12, v7
    v_sub_u32 v8, v5, v8
    v_lshl_add_u32 v8, v8, 4, s26
    v_min_u32 v8, 2736, v8
    v_mul_u32_u24 v7, 2752, v7
    v_add3_u32 v206, v7, v8, s27
    v_subrev_u32 v206, 2048, v206
    s_add_u32 s26, s69, s68
    s_and_b32 s26, s26, 3
    s_mov_b32 s89, 0x76543210
    s_cmp_eq_u32 s26, 1
    s_cselect_b32 s89, 0x10765432, s89
    s_cmp_eq_u32 s26, 2
    s_cselect_b32 s89, 0x32107654, s89
    s_cmp_eq_u32 s26, 3
    s_cselect_b32 s89, 0x54321076, s89
    s_and_b32 s73, s89, 7
    s_lshl_b32 s76, s66, 12
    s_mul_i32 s77, s66, 3072
    s_add_u32 s77, s77, 16384
    s_lshl_b32 s74, s73, 7
    s_mul_i32 s75, s73, 176128
    s_lshl_b32 s26, s67, 2
    s_waitcnt lgkmcnt(0)
    s_load_dword s71, s[18:19], s26
    s_load_dword s72, s[20:21], s26
    global_load_short_d16_hi v184, v198, s[6:7]
    global_load_short_d16_hi v185, v198, s[8:9]
    global_load_short_d16_hi v186, v198, s[10:11]
    global_load_short_d16_hi v187, v198, s[12:13]
    global_load_short_d16_hi v188, v198, s[14:15]
    global_load_short_d16_hi v189, v198, s[16:17]
    buffer_load_dwordx4 v[50:53], v3, s[36:39], 0 offen
    buffer_load_dwordx4 v[54:57], v3, s[36:39], 0 offen offset:1024
    s_barrier
    s_mov_b32 m0, s76
    s_nop 0
    buffer_load_dwordx4 v200, s[36:39], s74 offen offset:0 lds
    buffer_load_dwordx4 v201, s[36:39], s74 offen offset:1024 lds
    buffer_load_dwordx4 v202, s[36:39], s74 offen offset:2048 lds
    buffer_load_dwordx4 v203, s[36:39], s74 offen offset:3072 lds
    s_mov_b32 m0, s77
    s_nop 0
    buffer_load_dwordx4 v204, s[40:43], s75 offen offset:0 lds
    buffer_load_dwordx4 v205, s[40:43], s75 offen offset:1024 lds
    buffer_load_dwordx4 v206, s[40:43], s75 offen offset:2048 lds
    s_add_u32 m0, m0, 12320
    v_lshrrev_b32 v2, 4, v1
    v_bfe_u32 v3, v1, 2, 2
    v_and_b32 v4, 3, v1
    v_and_b32 v5, 31, v1
    v_lshrrev_b32 v6, 5, v1
    v_and_b32 v7, 15, v1
    s_and_b32 s26, s66, 1
    s_lshr_b32 s27, s66, 1
    v_bfe_u32 v8, v1, 1, 3
    v_xor_b32 v8, v8, v6
    v_lshlrev_b32 v8, 4, v8
    v_lshl_add_u32 v8, v5, 7, v8
    s_lshl_b32 s28, s26, 13
    v_add_u32 v207, s28, v8
    v_xor_b32 v208, 32, v207
    v_xor_b32 v209, 64, v207
    v_xor_b32 v210, 0x60, v207
    v_and_b32 v8, 1, v2
    v_mul_u32_u24 v9, 12320, v8
    v_lshl_add_u32 v18, v6, 3, v3
    v_mul_u32_u24 v18, 192, v18
    v_add_u32 v9, v9, v18
    v_lshl_add_u32 v9, v4, 3, v9
    s_mul_i32 s28, s27, 96
    s_add_u32 s28, s28, 16384
    v_add_u32 v211, s28, v9
    v_lshlrev_b32 v9, 4, v0
    v_add_u32 v212, 123648, v9
    s_lshl_b32 s28, s67, 1
    s_add_u32 s28, s28, s27
    s_lshl_b32 s28, s28, 12
    s_lshl_b32 s29, s26, 11
    s_add_u32 s28, s28, s29
    s_add_u32 s28, s28, 10485760
    v_lshlrev_b32 v9, 9, v8
    v_lshl_add_u32 v9, v7, 5, v9
    v_lshl_add_u32 v9, v6, 4, v9
    v_add_u32 v247, s28, v9
    s_lshr_b32 s28, s65, 3
    s_lshl_b32 s32, s64, 2
    s_add_u32 s32, s32, s28
    s_and_b32 s33, s65, 7
    s_lshl_b32 s28, s69, 4
    s_add_u32 s28, s28, s68
    s_lshl_b32 s28, s28, 7
    s_add_u32 s28, s28, 2162688
    s_cmp_ge_u32 s65, 30
    s_cselect_b32 s94, 2164608, s28
    s_cselect_b32 s28, 0x80000000, s28
    s_lshl_b32 s95, s67, 7
    s_add_u32 s95, s95, 2195456
    s_cmp_eq_u32 s66, 0
    s_cselect_b32 s81, s28, 0x80000000
    s_cselect_b32 s82, s95, 0x80000000
    s_mov_b32 s86, 1
    s_and_b32 s64, s2, 3
    s_lshl_b32 s64, s64, 6
    s_mul_i32 s28, s66, 2560
    s_add_u32 s28, s28, 141056
    v_mul_u32_u24 v9, 320, v3
    v_lshl_add_u32 v9, v2, 5, v9
    v_lshl_add_u32 v9, v4, 3, v9
    v_add_u32 v10, s28, v9
    s_mul_i32 s28, s66, 640
    s_add_u32 s28, s28, 141056
    v_mul_u32_u24 v9, 2560, v2
    v_lshl_add_u32 v9, v7, 4, v9
    v_add_u32 v11, s28, v9
    s_lshl_b32 s28, s70, 6
    s_lshl_b32 s29, s66, 4
    s_add_u32 s28, s28, s29
    s_add_u32 s28, s28, 2097152
    v_lshl_add_u32 v9, v6, 3, s28
    v_cmp_eq_u32 vcc, 0, v5
    v_mov_b32 v18, 0x80000000
    s_lshl_b32 s28, s70, 13
    s_lshl_b32 s29, s66, 11
    v_cndmask_b32 v15, v18, v9, vcc
    s_add_u32 s28, s28, s29
    v_lshl_add_u32 v14, v1, 4, s28
    v_writelane_b32 v15, s81, 1
    s_mul_i32 s28, s66, 4352
    s_add_u32 s70, s28, 123684
    s_waitcnt lgkmcnt(0)
    s_lshl_b32 s28, s27, 4
    s_lshr_b32 s71, s71, s28
    s_lshl_b32 s71, s71, 16
    s_lshr_b32 s72, s72, s28
    s_lshl_b32 s72, s72, 16
    s_cmp_eq_u32 s26, 0
    s_cselect_b32 s72, s72, 0
    v_accvgpr_write_b32 a164, 0
    v_accvgpr_write_b32 a165, 0
    v_accvgpr_write_b32 a166, 0
    v_accvgpr_write_b32 a167, 0
    v_accvgpr_write_b32 a168, -1
    v_accvgpr_write_b32 a169, -1
    v_accvgpr_write_b32 a170, -1
    v_accvgpr_write_b32 a171, -1
    v_lshlrev_b32 v9, 3, v0
    s_mov_b32 s79, 12960
    v_sub_u32 v18, 2047, v9
    s_mov_b32 s80, 30640
    v_cvt_f32_i32 v18, v18
    v_sub_u32 v19, 32031, v9
    v_min_i32 v19, 30122, v19
    v_subrev_f32 v24, 0.0, v18
    v_subrev_f32 v25, 1.0, v24
    v_cvt_pk_bf16_f32 v24, v24, v25
    v_subrev_u32 v26, 0, v19
    v_add_u32_sdwa v25, s79, v24 dst_sel:DWORD dst_unused:UNUSED_PAD src0_sel:DWORD src1_sel:WORD_0
    v_med3_i32 v25, v25, v26, s80
    v_lshrrev_b32 v26, 5, v25
    v_add_lshl_u32 v213, v25, v26, 2
    v_subrev_u32 v26, 1, v19
    v_add_u32_sdwa v25, s79, v24 dst_sel:DWORD dst_unused:UNUSED_PAD src0_sel:DWORD src1_sel:WORD_1
    v_med3_i32 v25, v25, v26, s80
    v_lshrrev_b32 v26, 5, v25
    v_add_lshl_u32 v214, v25, v26, 2
    v_subrev_f32 v24, 2.0, v18
    v_subrev_f32 v25, 1.0, v24
    v_cvt_pk_bf16_f32 v24, v24, v25
    v_subrev_u32 v26, 2, v19
    v_add_u32_sdwa v25, s79, v24 dst_sel:DWORD dst_unused:UNUSED_PAD src0_sel:DWORD src1_sel:WORD_0
    v_med3_i32 v25, v25, v26, s80
    v_lshrrev_b32 v26, 5, v25
    v_add_lshl_u32 v215, v25, v26, 2
    v_subrev_u32 v26, 3, v19
    v_add_u32_sdwa v25, s79, v24 dst_sel:DWORD dst_unused:UNUSED_PAD src0_sel:DWORD src1_sel:WORD_1
    v_med3_i32 v25, v25, v26, s80
    v_lshrrev_b32 v26, 5, v25
    v_add_lshl_u32 v216, v25, v26, 2
    v_subrev_f32 v24, 4.0, v18
    v_subrev_f32 v25, 1.0, v24
    v_cvt_pk_bf16_f32 v24, v24, v25
    v_subrev_u32 v26, 4, v19
    v_add_u32_sdwa v25, s79, v24 dst_sel:DWORD dst_unused:UNUSED_PAD src0_sel:DWORD src1_sel:WORD_0
    v_med3_i32 v25, v25, v26, s80
    v_lshrrev_b32 v26, 5, v25
    v_add_lshl_u32 v217, v25, v26, 2
    v_subrev_u32 v26, 5, v19
    v_add_u32_sdwa v25, s79, v24 dst_sel:DWORD dst_unused:UNUSED_PAD src0_sel:DWORD src1_sel:WORD_1
    v_med3_i32 v25, v25, v26, s80
    v_lshrrev_b32 v26, 5, v25
    v_add_lshl_u32 v218, v25, v26, 2
    v_subrev_f32 v24, 0x40c00000, v18
    v_subrev_f32 v25, 1.0, v24
    v_cvt_pk_bf16_f32 v24, v24, v25
    v_subrev_u32 v26, 6, v19
    v_add_u32_sdwa v25, s79, v24 dst_sel:DWORD dst_unused:UNUSED_PAD src0_sel:DWORD src1_sel:WORD_0
    v_med3_i32 v25, v25, v26, s80
    v_lshrrev_b32 v26, 5, v25
    v_add_lshl_u32 v219, v25, v26, 2
    v_subrev_u32 v26, 7, v19
    v_add_u32_sdwa v25, s79, v24 dst_sel:DWORD dst_unused:UNUSED_PAD src0_sel:DWORD src1_sel:WORD_1
    v_med3_i32 v25, v25, v26, s80
    v_lshrrev_b32 v26, 5, v25
    v_add_lshl_u32 v220, v25, v26, 2
    v_subrev_f32 v24, 0x41000000, v18
    v_subrev_f32 v25, 1.0, v24
    v_cvt_pk_bf16_f32 v24, v24, v25
    v_subrev_u32 v26, 8, v19
    v_add_u32_sdwa v25, s79, v24 dst_sel:DWORD dst_unused:UNUSED_PAD src0_sel:DWORD src1_sel:WORD_0
    v_med3_i32 v25, v25, v26, s80
    v_lshrrev_b32 v26, 5, v25
    v_add_lshl_u32 v221, v25, v26, 2
    v_subrev_u32 v26, 9, v19
    v_add_u32_sdwa v25, s79, v24 dst_sel:DWORD dst_unused:UNUSED_PAD src0_sel:DWORD src1_sel:WORD_1
    v_med3_i32 v25, v25, v26, s80
    v_lshrrev_b32 v26, 5, v25
    v_add_lshl_u32 v222, v25, v26, 2
    v_subrev_f32 v24, 0x41200000, v18
    v_subrev_f32 v25, 1.0, v24
    v_cvt_pk_bf16_f32 v24, v24, v25
    v_subrev_u32 v26, 10, v19
    v_add_u32_sdwa v25, s79, v24 dst_sel:DWORD dst_unused:UNUSED_PAD src0_sel:DWORD src1_sel:WORD_0
    v_med3_i32 v25, v25, v26, s80
    v_lshrrev_b32 v26, 5, v25
    v_add_lshl_u32 v223, v25, v26, 2
    v_lshrrev_b32 v9, 2, v7
    v_lshl_add_u32 v9, v7, 3, v9
    v_lshl_add_u32 v9, v8, 2, v9
    v_mul_u32_u24 v27, 132, v6
    v_add_lshl_u32 v9, v9, v27, 2
    v_add_u32 v255, s70, v9
    v_sub_u32 v9, 2, v6
    v_lshlrev_b32 v9, v9, v7
    v_lshl_add_u32 v27, v6, 1, 3
    v_lshrrev_b32 v27, v27, v7
    v_mul_u32_u24 v28, 66, v2
    v_add3_u32 v9, v9, v27, v28
    s_add_u32 s79, s70, 1056
    v_lshl_add_u32 v193, v9, 2, s79
    v_mul_u32_u24 v27, 124, v6
    v_add3_u32 v194, v193, v27, 8
    v_add_lshl_u32 v9, v28, v7, 2
    s_add_u32 s79, s70, 2112
    v_add_u32 v195, s79, v9
    s_sub_u32 s79, s70, 36
    v_lshl_add_u32 v251, v1, 4, s79
    v_lshl_add_u32 v9, v2, 3, v3
    v_lshlrev_b32 v9, 4, v9
    v_lshrrev_b32 v27, 1, v4
    v_mul_u32_u24 v27, 1088, v27
    v_and_b32 v28, 1, v4
    v_lshl_add_u32 v9, v28, 3, v9
    v_add3_u32 v252, v9, v27, s79
    v_and_b32 v9, 7, v1
    v_mul_u32_u24 v9, 4160, v9
    v_lshlrev_b32 v27, 1, v1
    v_and_b32 v27, 16, v27
    v_add_u32 v9, 127744, v9
    v_add_u32 v254, v9, v27
    s_mul_i32 s28, s68, 6
    s_mul_i32 s29, s27, 3
    s_add_u32 s28, s28, s29
    s_lshl_b32 s29, s28, 7
    s_add_u32 s29, s29, 12582912
    v_lshl_add_u32 v9, v1, 2, s29
    v_lshl_or_b32 v241, v6, 31, v9
    s_add_u32 s29, s28, 0
    s_cmp_lt_u32 s29, 86
    s_cselect_b32 s83, 0, 0x80000000
    s_lshl_b32 s29, s29, 10
    s_or_b32 s29, s29, s83
    v_lshl_add_u32 v234, v1, 4, s29
    s_add_u32 s29, s28, 1
    s_cmp_lt_u32 s29, 86
    s_cselect_b32 s83, 0, 0x80000000
    s_lshl_b32 s29, s29, 10
    s_or_b32 s29, s29, s83
    v_lshl_add_u32 v235, v1, 4, s29
    s_add_u32 s29, s28, 2
    s_cmp_lt_u32 s29, 86
    s_cselect_b32 s83, 0, 0x80000000
    s_lshl_b32 s29, s29, 10
    s_or_b32 s29, s29, s83
    v_lshl_add_u32 v236, v1, 4, s29
    s_lshl_b32 s28, s69, 1
    s_add_u32 s28, s28, s26
    s_lshl_b32 s29, s28, 9
    s_add_u32 s29, s29, 2097152
    v_lshl_add_u32 v240, v5, 3, s29
    s_mul_i32 s83, s28, 176128
    s_add_u32 s83, s83, 4194304
    s_add_u32 s84, s83, 88064
    v_lshlrev_b32 v253, 6, v4
    v_accvgpr_write_b32 a145, 0
    v_accvgpr_write_b32 a147, 0
    v_accvgpr_write_b32 a149, 0
    v_accvgpr_write_b32 a151, 0
    v_accvgpr_write_b32 a153, 0
    v_lshrrev_b32 v9, 1, v0
    v_and_b32 v192, 1, v0
    s_lshl_b32 s28, s67, 5
    v_lshl_add_u32 v198, v192, 4, s28
    v_lshl_add_u32 v237, v9, 13, v198
    v_mul_u32_u24 v192, 37888, v192
    v_lshl_add_u32 v192, v9, 4, v192
    v_add_u32 v238, 119520, v192
    v_min_u32 v9, 29, v5
    v_mul_u32_u24 v192, 37888, v6
    v_lshl_add_u32 v192, v9, 4, v192
    v_add_u32 v239, 119040, v192
    s_mov_b32 s30, 0x100000
    v_mov_b32 v60, s71
    v_mul_f32 v60, 0x3fb8aa3b, v60
    v_exp_f32 v60, v60
    s_nop 0
    v_cvt_pk_bf16_f32 v60, v60, v60
    v_and_b32 v60, s85, v60
    s_waitcnt vmcnt(9)
    buffer_load_dwordx4 v204, s[44:47], s75 offen offset:0 lds
    buffer_load_dwordx4 v205, s[44:47], s75 offen offset:1024 lds
    buffer_load_dwordx4 v206, s[44:47], s75 offen offset:2048 lds
    s_lshr_b32 s89, s89, 4
    s_and_b32 s73, s89, 7
    s_lshl_b32 s74, s73, 7
    s_mul_i32 s75, s73, 176128
    v_pk_mul_f32 v[184:185], v[184:185], v[60:61] op_sel_hi:[1,0]
    v_pk_mul_f32 v[186:187], v[186:187], v[60:61] op_sel_hi:[1,0]
    v_mul_f32 v184, 0x3fb8aa3b, v184
    v_mul_f32 v185, 0.15915494, v185
    v_mul_f32 v180, 0x41000000, v184
    v_mul_f32 v181, 0x41000000, v185
    v_mul_f32 v182, 0x43000000, v184
    v_mul_f32 v183, 0x43000000, v185
    v_exp_f32 v180, v180
    v_exp_f32 v178, v184
    v_exp_f32 v182, v182
    v_fract_f32 v181, v181
    v_fract_f32 v179, v185
    v_fract_f32 v183, v183
    v_pk_mul_f32 v[64:65], v[188:189], v[186:187] op_sel:[0,0] op_sel_hi:[0,1]
    v_pk_fma_f32 v[60:61], v[188:189], v[186:187], v[64:65] op_sel:[1,1,0] op_sel_hi:[1,0,1] neg_lo:[1,0,0]
    v_cos_f32 v174, v181
    v_sin_f32 v175, v181
    v_cos_f32 v172, v179
    v_sin_f32 v173, v179
    v_cos_f32 v176, v183
    v_sin_f32 v177, v183
    v_pk_mul_f32 v[174:175], v[174:175], v[180:181] op_sel_hi:[1,0]
    v_pk_mul_f32 v[172:173], v[172:173], v[178:179] op_sel_hi:[1,0]
    v_pk_mul_f32 v[176:177], v[176:177], v[182:183] op_sel_hi:[1,0]
    v_pk_mul_f32 v[64:65], v[60:61], v[174:175] op_sel:[0,0] op_sel_hi:[0,1]
    v_cvt_pk_bf16_f32 v128, 1.0, v172
    v_pk_fma_f32 v[62:63], v[60:61], v[174:175], v[64:65] op_sel:[1,1,0] op_sel_hi:[1,0,1] neg_lo:[1,0,0]
    v_cvt_pk_bf16_f32 v136, 0, v173
    v_cvt_pk_bf16_f32 v112, v60, v62
    v_pk_mul_f32 v[70:71], v[172:173], v[172:173] op_sel:[0,0] op_sel_hi:[0,1]
    v_cvt_pk_bf16_f32 v120, -v61, -v63
    v_pk_fma_f32 v[178:179], v[172:173], v[172:173], v[70:71] op_sel:[1,1,0] op_sel_hi:[1,0,1] neg_lo:[1,0,0]
    v_pk_mul_f32 v[64:65], v[62:63], v[174:175] op_sel:[0,0] op_sel_hi:[0,1]
    v_pk_mul_f32 v[70:71], v[178:179], v[172:173] op_sel:[0,0] op_sel_hi:[0,1]
    v_pk_fma_f32 v[60:61], v[62:63], v[174:175], v[64:65] op_sel:[1,1,0] op_sel_hi:[1,0,1] neg_lo:[1,0,0]
    v_pk_fma_f32 v[180:181], v[178:179], v[172:173], v[70:71] op_sel:[1,1,0] op_sel_hi:[1,0,1] neg_lo:[1,0,0]
    v_pk_mul_f32 v[64:65], v[60:61], v[174:175] op_sel:[0,0] op_sel_hi:[0,1]
    v_cvt_pk_bf16_f32 v129, v178, v180
    v_pk_fma_f32 v[62:63], v[60:61], v[174:175], v[64:65] op_sel:[1,1,0] op_sel_hi:[1,0,1] neg_lo:[1,0,0]
    v_cvt_pk_bf16_f32 v137, v179, v181
    v_cvt_pk_bf16_f32 v113, v60, v62
    v_pk_mul_f32 v[70:71], v[180:181], v[172:173] op_sel:[0,0] op_sel_hi:[0,1]
    v_cvt_pk_bf16_f32 v121, -v61, -v63
    v_pk_fma_f32 v[182:183], v[180:181], v[172:173], v[70:71] op_sel:[1,1,0] op_sel_hi:[1,0,1] neg_lo:[1,0,0]
    v_pk_mul_f32 v[64:65], v[62:63], v[174:175] op_sel:[0,0] op_sel_hi:[0,1]
    v_pk_mul_f32 v[70:71], v[182:183], v[172:173] op_sel:[0,0] op_sel_hi:[0,1]
    v_pk_fma_f32 v[60:61], v[62:63], v[174:175], v[64:65] op_sel:[1,1,0] op_sel_hi:[1,0,1] neg_lo:[1,0,0]
    v_pk_mul_f32 v[64:65], v[60:61], v[174:175] op_sel:[0,0] op_sel_hi:[0,1]
    v_pk_fma_f32 v[184:185], v[182:183], v[172:173], v[70:71] op_sel:[1,1,0] op_sel_hi:[1,0,1] neg_lo:[1,0,0]
    v_pk_fma_f32 v[62:63], v[60:61], v[174:175], v[64:65] op_sel:[1,1,0] op_sel_hi:[1,0,1] neg_lo:[1,0,0]
    v_cvt_pk_bf16_f32 v130, v182, v184
    v_cvt_pk_bf16_f32 v114, v60, v62
    v_cvt_pk_bf16_f32 v138, v183, v185
    s_add_u32 m0, s76, 41216
    s_nop 0
    buffer_load_dwordx4 v200, s[36:39], s74 offen offset:0 lds
    v_cvt_pk_bf16_f32 v122, -v61, -v63
    v_pk_mul_f32 v[70:71], v[184:185], v[172:173] op_sel:[0,0] op_sel_hi:[0,1]
    v_pk_mul_f32 v[64:65], v[62:63], v[174:175] op_sel:[0,0] op_sel_hi:[0,1]
    v_pk_fma_f32 v[186:187], v[184:185], v[172:173], v[70:71] op_sel:[1,1,0] op_sel_hi:[1,0,1] neg_lo:[1,0,0]
    v_pk_fma_f32 v[60:61], v[62:63], v[174:175], v[64:65] op_sel:[1,1,0] op_sel_hi:[1,0,1] neg_lo:[1,0,0]
    v_pk_mul_f32 v[70:71], v[186:187], v[172:173] op_sel:[0,0] op_sel_hi:[0,1]
    v_pk_mul_f32 v[64:65], v[60:61], v[174:175] op_sel:[0,0] op_sel_hi:[0,1]
    v_pk_fma_f32 v[188:189], v[186:187], v[172:173], v[70:71] op_sel:[1,1,0] op_sel_hi:[1,0,1] neg_lo:[1,0,0]
    v_pk_fma_f32 v[62:63], v[60:61], v[174:175], v[64:65] op_sel:[1,1,0] op_sel_hi:[1,0,1] neg_lo:[1,0,0]
    v_cvt_pk_bf16_f32 v131, v186, v188
    v_cvt_pk_bf16_f32 v115, v60, v62
    v_cvt_pk_bf16_f32 v139, v187, v189
    v_cvt_pk_bf16_f32 v123, -v61, -v63
    v_pk_mul_f32 v[70:71], v[176:177], v[172:173] op_sel:[0,0] op_sel_hi:[0,1]
    v_pk_mul_f32 v[64:65], v[62:63], v[174:175] op_sel:[0,0] op_sel_hi:[0,1]
    v_pk_fma_f32 v[68:69], v[176:177], v[172:173], v[70:71] op_sel:[1,1,0] op_sel_hi:[1,0,1] neg_lo:[1,0,0]
    v_pk_fma_f32 v[60:61], v[62:63], v[174:175], v[64:65] op_sel:[1,1,0] op_sel_hi:[1,0,1] neg_lo:[1,0,0]
    v_pk_mul_f32 v[64:65], v[60:61], v[174:175] op_sel:[0,0] op_sel_hi:[0,1]
    v_cvt_pk_bf16_f32 v132, v176, v68
    v_pk_fma_f32 v[62:63], v[60:61], v[174:175], v[64:65] op_sel:[1,1,0] op_sel_hi:[1,0,1] neg_lo:[1,0,0]
    v_cvt_pk_bf16_f32 v140, v177, v69
    v_cvt_pk_bf16_f32 v116, v60, v62
    v_pk_mul_f32 v[70:71], v[176:177], v[178:179] op_sel:[0,0] op_sel_hi:[0,1]
    v_cvt_pk_bf16_f32 v124, -v61, -v63
    v_pk_fma_f32 v[66:67], v[176:177], v[178:179], v[70:71] op_sel:[1,1,0] op_sel_hi:[1,0,1] neg_lo:[1,0,0]
    v_pk_mul_f32 v[64:65], v[62:63], v[174:175] op_sel:[0,0] op_sel_hi:[0,1]
    v_pk_mul_f32 v[70:71], v[176:177], v[180:181] op_sel:[0,0] op_sel_hi:[0,1]
    v_pk_fma_f32 v[60:61], v[62:63], v[174:175], v[64:65] op_sel:[1,1,0] op_sel_hi:[1,0,1] neg_lo:[1,0,0]
    v_pk_fma_f32 v[68:69], v[176:177], v[180:181], v[70:71] op_sel:[1,1,0] op_sel_hi:[1,0,1] neg_lo:[1,0,0]
    v_pk_mul_f32 v[64:65], v[60:61], v[174:175] op_sel:[0,0] op_sel_hi:[0,1]
    v_cvt_pk_bf16_f32 v133, v66, v68
    v_pk_fma_f32 v[62:63], v[60:61], v[174:175], v[64:65] op_sel:[1,1,0] op_sel_hi:[1,0,1] neg_lo:[1,0,0]
    v_cvt_pk_bf16_f32 v141, v67, v69
    v_cvt_pk_bf16_f32 v117, v60, v62
    v_pk_mul_f32 v[70:71], v[176:177], v[182:183] op_sel:[0,0] op_sel_hi:[0,1]
    v_cvt_pk_bf16_f32 v125, -v61, -v63
    v_pk_fma_f32 v[66:67], v[176:177], v[182:183], v[70:71] op_sel:[1,1,0] op_sel_hi:[1,0,1] neg_lo:[1,0,0]
    v_pk_mul_f32 v[64:65], v[62:63], v[174:175] op_sel:[0,0] op_sel_hi:[0,1]
    v_pk_mul_f32 v[70:71], v[176:177], v[184:185] op_sel:[0,0] op_sel_hi:[0,1]
    v_pk_fma_f32 v[60:61], v[62:63], v[174:175], v[64:65] op_sel:[1,1,0] op_sel_hi:[1,0,1] neg_lo:[1,0,0]
    v_pk_mul_f32 v[64:65], v[60:61], v[174:175] op_sel:[0,0] op_sel_hi:[0,1]
    v_pk_fma_f32 v[68:69], v[176:177], v[184:185], v[70:71] op_sel:[1,1,0] op_sel_hi:[1,0,1] neg_lo:[1,0,0]
    v_pk_fma_f32 v[62:63], v[60:61], v[174:175], v[64:65] op_sel:[1,1,0] op_sel_hi:[1,0,1] neg_lo:[1,0,0]
    v_cvt_pk_bf16_f32 v134, v66, v68
    v_cvt_pk_bf16_f32 v118, v60, v62
    v_cvt_pk_bf16_f32 v142, v67, v69
    v_cvt_pk_bf16_f32 v126, -v61, -v63
    v_pk_mul_f32 v[70:71], v[176:177], v[186:187] op_sel:[0,0] op_sel_hi:[0,1]
    v_pk_mul_f32 v[64:65], v[62:63], v[174:175] op_sel:[0,0] op_sel_hi:[0,1]
    v_pk_fma_f32 v[66:67], v[176:177], v[186:187], v[70:71] op_sel:[1,1,0] op_sel_hi:[1,0,1] neg_lo:[1,0,0]
    v_pk_fma_f32 v[60:61], v[62:63], v[174:175], v[64:65] op_sel:[1,1,0] op_sel_hi:[1,0,1] neg_lo:[1,0,0]
    v_pk_mul_f32 v[70:71], v[176:177], v[188:189] op_sel:[0,0] op_sel_hi:[0,1]
    v_pk_mul_f32 v[64:65], v[60:61], v[174:175] op_sel:[0,0] op_sel_hi:[0,1]
    v_pk_fma_f32 v[68:69], v[176:177], v[188:189], v[70:71] op_sel:[1,1,0] op_sel_hi:[1,0,1] neg_lo:[1,0,0]
    buffer_load_dwordx4 v201, s[36:39], s74 offen offset:1024 lds
    v_pk_fma_f32 v[62:63], v[60:61], v[174:175], v[64:65] op_sel:[1,1,0] op_sel_hi:[1,0,1] neg_lo:[1,0,0]
    v_cvt_pk_bf16_f32 v135, v66, v68
    v_cvt_pk_bf16_f32 v119, v60, v62
    v_cvt_pk_bf16_f32 v143, v67, v69
    v_cvt_pk_bf16_f32 v127, -v61, -v63
    v_pk_mul_f32 v[78:79], v[176:177], v[176:177] op_sel:[0,0] op_sel_hi:[0,1]
    ds_write_b128 v251, v[128:131] offset:0
    v_pk_mul_f32 v[84:85], v[176:177], v[176:177] op_sel:[0,0] op_sel_hi:[0,1]
    v_pk_fma_f32 v[72:73], v[176:177], v[176:177], v[78:79] op_sel:[1,1,0] op_sel_hi:[1,0,1] neg_lo:[1,0,0]
    v_pk_fma_f32 v[80:81], v[176:177], v[176:177], v[84:85] op_sel:[1,1,0] op_sel_hi:[1,0,1] neg_lo:[1,0,0]
    v_pk_mul_f32 v[78:79], v[72:73], v[178:179] op_sel:[0,0] op_sel_hi:[0,1]
    v_pk_mul_f32 v[84:85], v[80:81], v[80:81] op_sel:[0,0] op_sel_hi:[0,1]
    v_pk_fma_f32 v[76:77], v[72:73], v[178:179], v[78:79] op_sel:[1,1,0] op_sel_hi:[1,0,1] neg_lo:[1,0,0]
    v_cvt_pk_bf16_f32 v144, v72, v76
    v_pk_fma_f32 v[80:81], v[80:81], v[80:81], v[84:85] op_sel:[1,1,0] op_sel_hi:[1,0,1] neg_lo:[1,0,0]
    v_cvt_pk_bf16_f32 v152, v73, v77
    v_pk_mul_f32 v[84:85], v[80:81], v[80:81] op_sel:[0,0] op_sel_hi:[0,1]
    v_pk_mul_f32 v[78:79], v[72:73], v[182:183] op_sel:[0,0] op_sel_hi:[0,1]
    v_pk_fma_f32 v[74:75], v[72:73], v[182:183], v[78:79] op_sel:[1,1,0] op_sel_hi:[1,0,1] neg_lo:[1,0,0]
    ds_write_b128 v251, v[132:135] offset:1088
    v_pk_fma_f32 v[82:83], v[80:81], v[80:81], v[84:85] op_sel:[1,1,0] op_sel_hi:[1,0,1] neg_lo:[1,0,0]
    v_pk_mul_f32 v[78:79], v[72:73], v[186:187] op_sel:[0,0] op_sel_hi:[0,1]
    v_pk_mul_f32 v[84:85], v[82:83], v[176:177] op_sel:[0,0] op_sel_hi:[0,1]
    v_pk_fma_f32 v[76:77], v[72:73], v[186:187], v[78:79] op_sel:[1,1,0] op_sel_hi:[1,0,1] neg_lo:[1,0,0]
    v_cvt_pk_bf16_f32 v145, v74, v76
    v_pk_fma_f32 v[80:81], v[82:83], v[176:177], v[84:85] op_sel:[1,1,0] op_sel_hi:[1,0,1] neg_lo:[1,0,0]
    v_cvt_pk_bf16_f32 v153, v75, v77
    v_cvt_pk_bf16_f32 v160, v82, v80
    v_pk_mul_f32 v[78:79], v[72:73], v[176:177] op_sel:[0,0] op_sel_hi:[0,1]
    v_pk_fma_f32 v[72:73], v[72:73], v[176:177], v[78:79] op_sel:[1,1,0] op_sel_hi:[1,0,1] neg_lo:[1,0,0]
    v_cvt_pk_bf16_f32 v164, v83, v81
    v_pk_mul_f32 v[78:79], v[72:73], v[178:179] op_sel:[0,0] op_sel_hi:[0,1]
    ds_write_b128 v251, v[136:139] offset:2176
    buffer_load_dwordx4 v202, s[36:39], s74 offen offset:2048 lds
    v_pk_mul_f32 v[84:85], v[80:81], v[176:177] op_sel:[0,0] op_sel_hi:[0,1]
    v_pk_fma_f32 v[76:77], v[72:73], v[178:179], v[78:79] op_sel:[1,1,0] op_sel_hi:[1,0,1] neg_lo:[1,0,0]
    v_cvt_pk_bf16_f32 v146, v72, v76
    v_pk_fma_f32 v[82:83], v[80:81], v[176:177], v[84:85] op_sel:[1,1,0] op_sel_hi:[1,0,1] neg_lo:[1,0,0]
    v_cvt_pk_bf16_f32 v154, v73, v77
    v_pk_mul_f32 v[84:85], v[82:83], v[176:177] op_sel:[0,0] op_sel_hi:[0,1]
    v_pk_mul_f32 v[78:79], v[72:73], v[182:183] op_sel:[0,0] op_sel_hi:[0,1]
    v_pk_fma_f32 v[74:75], v[72:73], v[182:183], v[78:79] op_sel:[1,1,0] op_sel_hi:[1,0,1] neg_lo:[1,0,0]
    v_pk_fma_f32 v[80:81], v[82:83], v[176:177], v[84:85] op_sel:[1,1,0] op_sel_hi:[1,0,1] neg_lo:[1,0,0]
    v_pk_mul_f32 v[78:79], v[72:73], v[186:187] op_sel:[0,0] op_sel_hi:[0,1]
    v_cvt_pk_bf16_f32 v161, v82, v80
    v_pk_fma_f32 v[76:77], v[72:73], v[186:187], v[78:79] op_sel:[1,1,0] op_sel_hi:[1,0,1] neg_lo:[1,0,0]
    ds_write_b128 v251, v[140:143] offset:3264
    v_cvt_pk_bf16_f32 v147, v74, v76
    ds_read_b64_tr_b16 a[40:41], v252 offset:0
    v_cvt_pk_bf16_f32 v165, v83, v81
    ds_read_b64_tr_b16 a[42:43], v252 offset:64
    v_cvt_pk_bf16_f32 v155, v75, v77
    ds_read_b64_tr_b16 a[44:45], v252 offset:2176
    v_pk_mul_f32 v[84:85], v[80:81], v[176:177] op_sel:[0,0] op_sel_hi:[0,1]
    ds_read_b64_tr_b16 a[46:47], v252 offset:2240
    v_pk_mul_f32 v[78:79], v[72:73], v[176:177] op_sel:[0,0] op_sel_hi:[0,1]
    ds_read_b64_tr_b16 a[48:49], v252 offset:512
    v_pk_fma_f32 v[72:73], v[72:73], v[176:177], v[78:79] op_sel:[1,1,0] op_sel_hi:[1,0,1] neg_lo:[1,0,0]
    ds_read_b64_tr_b16 a[50:51], v252 offset:576
    buffer_load_dwordx4 v203, s[36:39], s74 offen offset:3072 lds
    v_pk_fma_f32 v[82:83], v[80:81], v[176:177], v[84:85] op_sel:[1,1,0] op_sel_hi:[1,0,1] neg_lo:[1,0,0]
    ds_read_b64_tr_b16 a[52:53], v252 offset:2688
    v_pk_mul_f32 v[78:79], v[72:73], v[182:183] op_sel:[0,0] op_sel_hi:[0,1]
    ds_read_b64_tr_b16 a[54:55], v252 offset:2752
    v_pk_mul_f32 v[84:85], v[82:83], v[176:177] op_sel:[0,0] op_sel_hi:[0,1]
    v_pk_fma_f32 v[76:77], v[72:73], v[182:183], v[78:79] op_sel:[1,1,0] op_sel_hi:[1,0,1] neg_lo:[1,0,0]
    v_cvt_pk_bf16_f32 v148, v72, v76
    v_pk_fma_f32 v[80:81], v[82:83], v[176:177], v[84:85] op_sel:[1,1,0] op_sel_hi:[1,0,1] neg_lo:[1,0,0]
    ds_write_b128 v251, v[112:115] offset:0
    v_cvt_pk_bf16_f32 v156, v73, v77
    v_cvt_pk_bf16_f32 v162, v82, v80
    v_pk_mul_f32 v[78:79], v[72:73], v[176:177] op_sel:[0,0] op_sel_hi:[0,1]
    v_pk_fma_f32 v[72:73], v[72:73], v[176:177], v[78:79] op_sel:[1,1,0] op_sel_hi:[1,0,1] neg_lo:[1,0,0]
    v_cvt_pk_bf16_f32 v166, v83, v81
    v_pk_mul_f32 v[78:79], v[72:73], v[182:183] op_sel:[0,0] op_sel_hi:[0,1]
    v_pk_mul_f32 v[84:85], v[80:81], v[176:177] op_sel:[0,0] op_sel_hi:[0,1]
    v_pk_fma_f32 v[76:77], v[72:73], v[182:183], v[78:79] op_sel:[1,1,0] op_sel_hi:[1,0,1] neg_lo:[1,0,0]
    v_cvt_pk_bf16_f32 v149, v72, v76
    v_pk_fma_f32 v[82:83], v[80:81], v[176:177], v[84:85] op_sel:[1,1,0] op_sel_hi:[1,0,1] neg_lo:[1,0,0]
    v_cvt_pk_bf16_f32 v157, v73, v77
    v_pk_mul_f32 v[84:85], v[82:83], v[176:177] op_sel:[0,0] op_sel_hi:[0,1]
    ds_write_b128 v251, v[116:119] offset:1088
    v_pk_mul_f32 v[78:79], v[72:73], v[176:177] op_sel:[0,0] op_sel_hi:[0,1]
    v_pk_fma_f32 v[72:73], v[72:73], v[176:177], v[78:79] op_sel:[1,1,0] op_sel_hi:[1,0,1] neg_lo:[1,0,0]
    v_pk_fma_f32 v[80:81], v[82:83], v[176:177], v[84:85] op_sel:[1,1,0] op_sel_hi:[1,0,1] neg_lo:[1,0,0]
    v_pk_mul_f32 v[78:79], v[72:73], v[182:183] op_sel:[0,0] op_sel_hi:[0,1]
    v_cvt_pk_bf16_f32 v163, v82, v80
    s_add_u32 m0, s77, 41216
    s_nop 0
    buffer_load_dwordx4 v204, s[40:43], s75 offen offset:0 lds
    v_pk_fma_f32 v[76:77], v[72:73], v[182:183], v[78:79] op_sel:[1,1,0] op_sel_hi:[1,0,1] neg_lo:[1,0,0]
    v_cvt_pk_bf16_f32 v150, v72, v76
    v_cvt_pk_bf16_f32 v167, v83, v81
    v_cvt_pk_bf16_f32 v158, v73, v77
    v_pk_mul_f32 v[84:85], v[80:81], v[176:177] op_sel:[0,0] op_sel_hi:[0,1]
    v_pk_mul_f32 v[78:79], v[72:73], v[176:177] op_sel:[0,0] op_sel_hi:[0,1]
    v_pk_fma_f32 v[72:73], v[72:73], v[176:177], v[78:79] op_sel:[1,1,0] op_sel_hi:[1,0,1] neg_lo:[1,0,0]
    ds_write_b128 v251, v[120:123] offset:2176
    v_pk_fma_f32 v[82:83], v[80:81], v[176:177], v[84:85] op_sel:[1,1,0] op_sel_hi:[1,0,1] neg_lo:[1,0,0]
    v_pk_mul_f32 v[78:79], v[72:73], v[182:183] op_sel:[0,0] op_sel_hi:[0,1]
    v_cvt_pk_bf16_f32 v168, v82, 0
    v_pk_fma_f32 v[76:77], v[72:73], v[182:183], v[78:79] op_sel:[1,1,0] op_sel_hi:[1,0,1] neg_lo:[1,0,0]
    v_cvt_pk_bf16_f32 v151, v72, v76
    v_cvt_pk_bf16_f32 v170, v83, 0
    v_cvt_pk_bf16_f32 v159, v73, v77
    v_mov_b32 v172, 0
    v_mov_b32 v173, 0
    v_mov_b32 v174, 0
    v_mov_b32 v175, 0
    v_writelane_b32 v172, s72, 0
    ds_write_b128 v251, v[124:127] offset:3264
    s_waitcnt vmcnt(15)
    ds_read_b64_tr_b16 a[24:25], v252 offset:0
    v_lshlrev_b32 v20, 16, v50
    ds_read_b64_tr_b16 a[26:27], v252 offset:64
    v_and_b32 v21, s85, v50
    ds_read_b64_tr_b16 a[28:29], v252 offset:2176
    buffer_load_dwordx4 v205, s[40:43], s75 offen offset:1024 lds
    v_lshlrev_b32 v22, 16, v51
    ds_read_b64_tr_b16 a[30:31], v252 offset:2240
    v_and_b32 v23, s85, v51
    ds_read_b64_tr_b16 a[32:33], v252 offset:512
    v_lshlrev_b32 v24, 16, v52
    ds_read_b64_tr_b16 a[34:35], v252 offset:576
    v_and_b32 v25, s85, v52
    ds_read_b64_tr_b16 a[36:37], v252 offset:2688
    v_lshlrev_b32 v26, 16, v53
    ds_read_b64_tr_b16 a[38:39], v252 offset:2752
    v_and_b32 v27, s85, v53
    v_lshlrev_b32 v28, 16, v54
    v_and_b32 v29, s85, v54
    v_lshlrev_b32 v30, 16, v55
    v_and_b32 v31, s85, v55
    v_lshlrev_b32 v32, 16, v56
    v_and_b32 v33, s85, v56
    v_lshlrev_b32 v34, 16, v57
    v_and_b32 v35, s85, v57
    v_pk_add_f32 v[36:37], v[20:21], v[22:23]
    v_pk_add_f32 v[38:39], v[24:25], v[26:27]
    v_pk_add_f32 v[36:37], v[36:37], v[38:39]
    v_add_f32 v40, v36, v37
    v_pk_add_f32 v[36:37], v[28:29], v[30:31]
    v_pk_add_f32 v[38:39], v[32:33], v[34:35]
    v_pk_add_f32 v[36:37], v[36:37], v[38:39]
    v_add_f32 v41, v36, v37
    s_nop 1
    v_permlane32_swap_b32 v40, v41
    v_add_f32 v40, v40, v41
    v_mov_b32 v41, v40
    s_nop 1
    v_permlane16_swap_b32 v40, v41
    v_add_f32 v40, v40, v41
    s_nop 1
    v_add_f32_dpp v40, v40, v40 row_ror:8 row_mask:0xf bank_mask:0xf
    s_nop 1
    v_add_f32_dpp v40, v40, v40 row_ror:4 row_mask:0xf bank_mask:0xf
    s_nop 1
    v_add_f32_dpp v40, v40, v40 row_ror:2 row_mask:0xf bank_mask:0xf
    s_nop 1
    v_add_f32_dpp v40, v40, v40 row_ror:1 row_mask:0xf bank_mask:0xf
    v_mul_f32 v40, 0x3b000000, v40
    v_mov_b32 v42, v40
    v_mov_b32 v43, v40
    buffer_load_dwordx4 v206, s[40:43], s75 offen offset:2048 lds
    v_cvt_pk_bf16_f32 v12, -v40, -v40
    s_nop 0
    v_permlane32_swap_b32 v42, v43
    v_pk_add_f32 v[38:39], v[20:21], v[42:43] op_sel:[0,0] op_sel_hi:[1,0] neg_lo:[0,1] neg_hi:[0,1]
    v_pk_mul_f32 v[36:37], v[38:39], v[38:39]
    v_pk_add_f32 v[38:39], v[22:23], v[42:43] op_sel:[0,0] op_sel_hi:[1,0] neg_lo:[0,1] neg_hi:[0,1]
    v_pk_fma_f32 v[36:37], v[38:39], v[38:39], v[36:37]
    v_pk_add_f32 v[38:39], v[24:25], v[42:43] op_sel:[0,0] op_sel_hi:[1,0] neg_lo:[0,1] neg_hi:[0,1]
    v_pk_fma_f32 v[36:37], v[38:39], v[38:39], v[36:37]
    v_pk_add_f32 v[38:39], v[26:27], v[42:43] op_sel:[0,0] op_sel_hi:[1,0] neg_lo:[0,1] neg_hi:[0,1]
    v_pk_fma_f32 v[36:37], v[38:39], v[38:39], v[36:37]
    v_add_f32 v40, v36, v37
    v_pk_add_f32 v[38:39], v[28:29], v[42:43] op_sel:[0,1] op_sel_hi:[1,1] neg_lo:[0,1] neg_hi:[0,1]
    v_pk_mul_f32 v[36:37], v[38:39], v[38:39]
    v_pk_add_f32 v[38:39], v[30:31], v[42:43] op_sel:[0,1] op_sel_hi:[1,1] neg_lo:[0,1] neg_hi:[0,1]
    v_pk_fma_f32 v[36:37], v[38:39], v[38:39], v[36:37]
    v_pk_add_f32 v[38:39], v[32:33], v[42:43] op_sel:[0,1] op_sel_hi:[1,1] neg_lo:[0,1] neg_hi:[0,1]
    v_pk_fma_f32 v[36:37], v[38:39], v[38:39], v[36:37]
    v_pk_add_f32 v[38:39], v[34:35], v[42:43] op_sel:[0,1] op_sel_hi:[1,1] neg_lo:[0,1] neg_hi:[0,1]
    v_pk_fma_f32 v[36:37], v[38:39], v[38:39], v[36:37]
    v_add_f32 v41, v36, v37
    s_nop 1
    v_permlane32_swap_b32 v40, v41
    v_add_f32 v40, v40, v41
    v_mov_b32 v41, v40
    s_nop 1
    v_permlane16_swap_b32 v40, v41
    v_add_f32 v40, v40, v41
    s_nop 1
    v_add_f32_dpp v40, v40, v40 row_ror:8 row_mask:0xf bank_mask:0xf
    s_nop 1
    v_add_f32_dpp v40, v40, v40 row_ror:4 row_mask:0xf bank_mask:0xf
    s_nop 1
    v_add_f32_dpp v40, v40, v40 row_ror:2 row_mask:0xf bank_mask:0xf
    s_nop 1
    v_add_f32_dpp v40, v40, v40 row_ror:1 row_mask:0xf bank_mask:0xf
    v_mul_f32 v40, 0x3b000000, v40
    v_cvt_pk_bf16_f32 v40, v40, v40
    v_and_b32 v40, s85, v40
    v_add_f32 v40, 0x3727c5ac, v40
    v_cvt_pk_bf16_f32 v40, v40, v40
    v_and_b32 v40, s85, v40
    v_sqrt_f32 v40, v40
    v_and_b32 v41, s85, v12
    v_cvt_pk_bf16_f32 v40, v40, v40
    v_and_b32 v40, s85, v40
    v_rcp_f32 v46, v40
    s_nop 0
    v_mul_f32 v47, v41, v46
    v_mul_f32 v13, v46, v46
    v_mov_b32 v48, v46
    v_mov_b32 v49, v47
    s_nop 1
    v_permlane32_swap_b32 v46, v48
    s_add_u32 m0, m0, 12320
    s_nop 0
    buffer_load_dwordx4 v204, s[44:47], s75 offen offset:0 lds
    v_permlane32_swap_b32 v47, v49
    v_pk_fma_f32 v[20:21], v[20:21], v[46:47], v[46:47] op_sel:[0,0,1] op_sel_hi:[1,0,1]
    v_cvt_pk_bf16_f32 v50, v20, v21
    v_pk_fma_f32 v[22:23], v[22:23], v[46:47], v[46:47] op_sel:[0,0,1] op_sel_hi:[1,0,1]
    v_cvt_pk_bf16_f32 v51, v22, v23
    v_pk_fma_f32 v[24:25], v[24:25], v[46:47], v[46:47] op_sel:[0,0,1] op_sel_hi:[1,0,1]
    v_cvt_pk_bf16_f32 v52, v24, v25
    v_pk_fma_f32 v[26:27], v[26:27], v[46:47], v[46:47] op_sel:[0,0,1] op_sel_hi:[1,0,1]
    v_cvt_pk_bf16_f32 v53, v26, v27
    ds_write_b128 v11, v[50:53] offset:0
    v_pk_fma_f32 v[28:29], v[28:29], v[48:49], v[48:49] op_sel:[0,0,1] op_sel_hi:[1,0,1]
    v_cvt_pk_bf16_f32 v54, v28, v29
    v_pk_fma_f32 v[30:31], v[30:31], v[48:49], v[48:49] op_sel:[0,0,1] op_sel_hi:[1,0,1]
    v_cvt_pk_bf16_f32 v55, v30, v31
    v_pk_fma_f32 v[32:33], v[32:33], v[48:49], v[48:49] op_sel:[0,0,1] op_sel_hi:[1,0,1]
    v_cvt_pk_bf16_f32 v56, v32, v33
    v_pk_fma_f32 v[34:35], v[34:35], v[48:49], v[48:49] op_sel:[0,0,1] op_sel_hi:[1,0,1]
    v_cvt_pk_bf16_f32 v57, v34, v35
    ds_write_b128 v11, v[54:57] offset:320
    buffer_load_dwordx4 v205, s[44:47], s75 offen offset:1024 lds
    buffer_load_dwordx4 v206, s[44:47], s75 offen offset:2048 lds
    s_lshr_b32 s89, s89, 4
    s_and_b32 s73, s89, 7
    s_lshl_b32 s74, s73, 7
    s_mul_i32 s75, s73, 176128
    s_cmp_ge_u32 s65, 30
    s_cbranch_scc1 CS_3
    s_waitcnt vmcnt(10) lgkmcnt(0)
    s_barrier
    ds_read_b128 a[188:191], v207 offset:0
    ds_read_b64_tr_b16 a[176:177], v211 offset:0
    ds_read_b64_tr_b16 a[178:179], v211 offset:768
    ds_read_b128 a[192:195], v207 offset:4096
    ds_read_b64_tr_b16 a[180:181], v211 offset:32
    ds_read_b64_tr_b16 a[182:183], v211 offset:800
    ds_read_b64_tr_b16 a[184:185], v211 offset:64
    ds_read_b64_tr_b16 a[186:187], v211 offset:832
    ds_read_b64_tr_b16 a[88:89], v10 offset:0
    ds_read_b64_tr_b16 a[90:91], v10 offset:1280
    ds_read_b64_tr_b16 a[92:93], v10 offset:128
    ds_read_b64_tr_b16 a[94:95], v10 offset:1408
    s_waitcnt lgkmcnt(4)
    v_mfma_f32_32x32x16_bf16 v[16:31], a[176:179], a[188:191], 0
    ds_read_b128 a[208:211], v208 offset:0
    ds_read_b64_tr_b16 a[196:197], v211 offset:3072
    ds_write_b128 v251, v[160:163] offset:0
    v_mfma_f32_32x32x16_bf16 v[32:47], a[176:179], a[192:195], 0
    ds_read_b64_tr_b16 a[198:199], v211 offset:3840
    ds_read_b128 a[212:215], v208 offset:4096
    ds_write_b32 v251, v168 offset:1088
    v_mfma_f32_32x32x16_bf16 v[48:63], a[180:183], a[188:191], 0
    ds_read_b64_tr_b16 a[200:201], v211 offset:3104
    ds_read_b64_tr_b16 a[202:203], v211 offset:3872
    ds_write_b128 v251, v[164:167] offset:2176
    v_mfma_f32_32x32x16_bf16 v[64:79], a[180:183], a[192:195], 0
    ds_read_b64_tr_b16 a[204:205], v211 offset:3136
    ds_read_b64_tr_b16 a[206:207], v211 offset:3904
    ds_write_b32 v251, v170 offset:3264
    ds_read_b64_tr_b16 a[72:73], v252 offset:0
    v_mfma_f32_32x32x16_bf16 v[80:95], a[184:187], a[188:191], 0
    ds_read_b64_tr_b16 a[74:75], v252 offset:64
    ds_read_b64_tr_b16 a[76:77], v252 offset:2176
    ds_read_b64_tr_b16 a[78:79], v252 offset:2240
    s_add_u32 m0, s76, 82432
    s_nop 0
    buffer_load_dwordx4 v200, s[36:39], s74 offen offset:0 lds
    v_mfma_f32_32x32x16_bf16 v[96:111], a[184:187], a[192:195], 0
    ds_read_b64_tr_b16 a[80:81], v252 offset:512
    ds_read_b64_tr_b16 a[82:83], v252 offset:576
    ds_read_b64_tr_b16 a[84:85], v252 offset:2688
    ds_read_b64_tr_b16 a[86:87], v252 offset:2752
    buffer_load_dwordx4 v201, s[36:39], s74 offen offset:1024 lds
    s_waitcnt lgkmcnt(9)
    v_mfma_f32_32x32x16_bf16 v[16:31], a[196:199], a[208:211], v[16:31]
    ds_read_b128 a[188:191], v209 offset:0
    ds_read_b64_tr_b16 a[176:177], v211 offset:6144
    ds_write_b128 v251, v[144:147] offset:0
    buffer_load_dwordx4 v202, s[36:39], s74 offen offset:2048 lds
    v_mfma_f32_32x32x16_bf16 v[32:47], a[196:199], a[212:215], v[32:47]
    ds_read_b64_tr_b16 a[178:179], v211 offset:6912
    ds_read_b128 a[192:195], v209 offset:4096
    buffer_load_dwordx4 v203, s[36:39], s74 offen offset:3072 lds
    v_mfma_f32_32x32x16_bf16 v[48:63], a[200:203], a[208:211], v[48:63]
    ds_read_b64_tr_b16 a[180:181], v211 offset:6176
    ds_read_b64_tr_b16 a[182:183], v211 offset:6944
    ds_write_b128 v251, v[148:151] offset:1088
    s_add_u32 m0, s77, 82432
    s_nop 0
    buffer_load_dwordx4 v204, s[40:43], s75 offen offset:0 lds
    v_mfma_f32_32x32x16_bf16 v[64:79], a[200:203], a[212:215], v[64:79]
    ds_read_b64_tr_b16 a[184:185], v211 offset:6208
    ds_read_b64_tr_b16 a[186:187], v211 offset:6976
    buffer_load_dwordx4 v205, s[40:43], s75 offen offset:1024 lds
    v_mfma_f32_32x32x16_bf16 v[80:95], a[204:207], a[208:211], v[80:95]
    ds_write_b128 v251, v[152:155] offset:2176
    buffer_load_dwordx4 v206, s[40:43], s75 offen offset:2048 lds
    v_mfma_f32_32x32x16_bf16 v[96:111], a[204:207], a[212:215], v[96:111]
    s_add_u32 m0, m0, 12320
    s_nop 0
    buffer_load_dwordx4 v204, s[44:47], s75 offen offset:0 lds
    s_waitcnt lgkmcnt(1)
    v_mfma_f32_32x32x16_bf16 v[16:31], a[176:179], a[188:191], v[16:31]
    ds_read_b128 a[208:211], v210 offset:0
    ds_read_b64_tr_b16 a[196:197], v211 offset:9216
    ds_write_b128 v251, v[156:159] offset:3264
    buffer_load_dwordx4 v205, s[44:47], s75 offen offset:1024 lds
    v_mfma_f32_32x32x16_bf16 v[32:47], a[176:179], a[192:195], v[32:47]
    ds_read_b64_tr_b16 a[198:199], v211 offset:9984
    ds_read_b128 a[212:215], v210 offset:4096
    ds_read_b64_tr_b16 a[56:57], v252 offset:0
    ds_read_b64_tr_b16 a[58:59], v252 offset:64
    buffer_load_dwordx4 v206, s[44:47], s75 offen offset:2048 lds
    s_lshr_b32 s89, s89, 4
    s_and_b32 s73, s89, 7
    s_lshl_b32 s74, s73, 7
    s_mul_i32 s75, s73, 176128
    v_mfma_f32_32x32x16_bf16 v[48:63], a[180:183], a[188:191], v[48:63]
    ds_read_b64_tr_b16 a[200:201], v211 offset:9248
    ds_read_b64_tr_b16 a[202:203], v211 offset:10016
    ds_read_b64_tr_b16 a[60:61], v252 offset:2176
    ds_read_b64_tr_b16 a[62:63], v252 offset:2240
    v_mfma_f32_32x32x16_bf16 v[64:79], a[180:183], a[192:195], v[64:79]
    ds_read_b64_tr_b16 a[204:205], v211 offset:9280
    ds_read_b64_tr_b16 a[206:207], v211 offset:10048
    ds_read_b64_tr_b16 a[64:65], v252 offset:512
    ds_read_b64_tr_b16 a[66:67], v252 offset:576
    v_mfma_f32_32x32x16_bf16 v[80:95], a[184:187], a[188:191], v[80:95]
    ds_read_b64_tr_b16 a[68:69], v252 offset:2688
    ds_read_b64_tr_b16 a[70:71], v252 offset:2752
    v_mfma_f32_32x32x16_bf16 v[96:111], a[184:187], a[192:195], v[96:111]
    s_waitcnt lgkmcnt(15)
    v_mfma_f32_16x16x32_bf16 v[172:175], a[40:43], a[24:27], v[172:175]
    v_writelane_b32 v12, 0, 1
    buffer_store_dwordx2 v[12:13], v15, s[52:55], 0 offen sc1
    v_mfma_f32_16x16x32_bf16 v[172:175], a[44:47], a[28:31], v[172:175]
    buffer_store_dwordx4 a[168:171], v247, s[52:55], 0 offen offset:0 sc1
    v_mfma_f32_16x16x32_bf16 v[172:175], a[48:51], a[32:35], v[172:175]
    buffer_store_dwordx4 a[168:171], v247, s[52:55], 0 offen offset:1024 sc1
    v_mfma_f32_16x16x32_bf16 v[172:175], a[52:55], a[36:39], v[172:175]
    s_waitcnt lgkmcnt(15)
    buffer_store_dwordx4 a[88:91], v14, s[52:55], 0 offen offset:0 sc1
    s_waitcnt lgkmcnt(0)
    v_mfma_f32_16x16x32_bf16 v[176:179], a[56:59], a[24:27], 0
    s_waitcnt lgkmcnt(15)
    buffer_store_dwordx4 a[92:95], v14, s[52:55], 0 offen offset:1024 sc1
    v_mfma_f32_16x16x32_bf16 v[176:179], a[60:63], a[28:31], v[176:179]
    v_mfma_f32_16x16x32_bf16 v[176:179], a[64:67], a[32:35], v[176:179]
    v_mfma_f32_16x16x32_bf16 v[176:179], a[68:71], a[36:39], v[176:179]
    s_waitcnt lgkmcnt(15)
    v_mfma_f32_16x16x32_bf16 v[180:183], a[72:75], a[24:27], 0
    v_mfma_f32_16x16x32_bf16 v[180:183], a[76:79], a[28:31], v[180:183]
    v_mfma_f32_16x16x32_bf16 v[180:183], a[80:83], a[32:35], v[180:183]
    v_mfma_f32_16x16x32_bf16 v[180:183], a[84:87], a[36:39], v[180:183]
    ds_write2_b32 v255, v172, v173 offset0:0 offset1:1
    ds_write2_b32 v255, v174, v175 offset0:2 offset1:3
    s_nop 0
    ds_write2_b32 v193, v176, v177 offset0:0 offset1:1
    ds_write2_b32 v194, v178, v179 offset0:0 offset1:1
    s_nop 2
    ds_write2_b32 v195, v180, v181 offset0:0 offset1:16
    ds_write2_b32 v195, v182, v183 offset0:33 offset1:49
    s_waitcnt lgkmcnt(0)
    v_mfma_f32_32x32x16_bf16 v[16:31], a[196:199], a[208:211], v[16:31]
    s_waitcnt vmcnt(15)
    s_barrier
    v_mfma_f32_32x32x16_bf16 v[32:47], a[196:199], a[212:215], v[32:47]
    ds_read_b128 a[188:191], v207 offset:41216
    ds_read_b64_tr_b16 a[176:177], v211 offset:41216
    ds_read_b64_tr_b16 a[178:179], v211 offset:41984
    ds_read_b128 a[192:195], v207 offset:45312
    ds_read_b64_tr_b16 a[180:181], v211 offset:41248
    v_mfma_f32_32x32x16_bf16 v[48:63], a[200:203], a[208:211], v[48:63]
    ds_read_b64_tr_b16 a[182:183], v211 offset:42016
    ds_read_b64_tr_b16 a[184:185], v211 offset:41280
    ds_read_b64_tr_b16 a[186:187], v211 offset:42048
    v_mfma_f32_32x32x16_bf16 v[64:79], a[200:203], a[212:215], v[64:79]
    v_mfma_f32_32x32x16_bf16 v[80:95], a[204:207], a[208:211], v[80:95]
    v_mfma_f32_32x32x16_bf16 v[96:111], a[204:207], a[212:215], v[96:111]
    s_waitcnt lgkmcnt(0)
    v_mfma_f32_32x32x16_bf16 v[16:31], a[176:179], a[188:191], v[16:31]
    ds_read_b128 a[208:211], v208 offset:41216
    ds_read_b64_tr_b16 a[196:197], v211 offset:44288
    s_mov_b32 m0, s76
    ds_read2st64_b32 v[112:113], v213 offset0:0 offset1:17
    ds_read2st64_b32 v[114:115], v214 offset0:0 offset1:17
    v_mfma_f32_32x32x16_bf16 v[32:47], a[176:179], a[192:195], v[32:47]
    ds_read_b64_tr_b16 a[198:199], v211 offset:45056
    ds_read_b128 a[212:215], v208 offset:45312
    buffer_load_dwordx4 v200, s[36:39], s74 offen offset:0 lds
    ds_read2st64_b32 v[116:117], v215 offset0:0 offset1:17
    ds_read2st64_b32 v[118:119], v216 offset0:0 offset1:17
    v_mfma_f32_32x32x16_bf16 v[48:63], a[180:183], a[188:191], v[48:63]
    ds_read_b64_tr_b16 a[200:201], v211 offset:44320
    ds_read_b64_tr_b16 a[202:203], v211 offset:45088
    buffer_load_dwordx4 v201, s[36:39], s74 offen offset:1024 lds
    ds_read2st64_b32 v[120:121], v217 offset0:0 offset1:17
    ds_read2st64_b32 v[122:123], v218 offset0:0 offset1:17
    v_mfma_f32_32x32x16_bf16 v[64:79], a[180:183], a[192:195], v[64:79]
    ds_read_b64_tr_b16 a[204:205], v211 offset:44352
    ds_read_b64_tr_b16 a[206:207], v211 offset:45120
    buffer_load_dwordx4 v202, s[36:39], s74 offen offset:2048 lds
    ds_read2st64_b32 v[124:125], v219 offset0:0 offset1:17
    ds_read2st64_b32 v[126:127], v220 offset0:0 offset1:17
    v_mfma_f32_32x32x16_bf16 v[80:95], a[184:187], a[188:191], v[80:95]
    buffer_load_dwordx4 v203, s[36:39], s74 offen offset:3072 lds
    ds_read2st64_b32 v[128:129], v221 offset0:0 offset1:17
    ds_read2st64_b32 v[130:131], v222 offset0:0 offset1:17
    v_mfma_f32_32x32x16_bf16 v[96:111], a[184:187], a[192:195], v[96:111]
    ds_read2st64_b32 v[132:133], v223 offset0:0 offset1:17
    ds_read2st64_b32 v[136:137], v213 offset0:34 offset1:51
    s_waitcnt lgkmcnt(6)
    v_mfma_f32_32x32x16_bf16 v[16:31], a[196:199], a[208:211], v[16:31]
    ds_read_b128 a[188:191], v209 offset:41216
    ds_read_b64_tr_b16 a[176:177], v211 offset:47360
    s_mov_b32 m0, s77
    ds_read2st64_b32 v[138:139], v214 offset0:34 offset1:51
    ds_read2st64_b32 v[140:141], v215 offset0:34 offset1:51
    v_mfma_f32_32x32x16_bf16 v[32:47], a[196:199], a[212:215], v[32:47]
    ds_read_b64_tr_b16 a[178:179], v211 offset:48128
    ds_read_b128 a[192:195], v209 offset:45312
    buffer_load_dwordx4 v204, s[40:43], s75 offen offset:0 lds
    s_waitcnt lgkmcnt(15)
    v_add_f32 v112, v112, v113
    v_add_f32 v114, v114, v115
    v_mfma_f32_32x32x16_bf16 v[48:63], a[200:203], a[208:211], v[48:63]
    ds_read_b64_tr_b16 a[180:181], v211 offset:47392
    ds_read_b64_tr_b16 a[182:183], v211 offset:48160
    buffer_load_dwordx4 v205, s[40:43], s75 offen offset:1024 lds
    ds_read2st64_b32 v[142:143], v216 offset0:34 offset1:51
    v_add_f32 v116, v116, v117
    v_mfma_f32_32x32x16_bf16 v[64:79], a[200:203], a[212:215], v[64:79]
    ds_read_b64_tr_b16 a[184:185], v211 offset:47424
    ds_read_b64_tr_b16 a[186:187], v211 offset:48192
    buffer_load_dwordx4 v206, s[40:43], s75 offen offset:2048 lds
    v_add_f32 v118, v118, v119
    ds_read2st64_b32 v[144:145], v217 offset0:34 offset1:51
    v_mfma_f32_32x32x16_bf16 v[80:95], a[204:207], a[208:211], v[80:95]
    s_waitcnt lgkmcnt(15)
    v_add_f32 v120, v120, v121
    v_add_f32 v122, v122, v123
    v_mfma_f32_32x32x16_bf16 v[96:111], a[204:207], a[212:215], v[96:111]
    ds_read2st64_b32 v[146:147], v218 offset0:34 offset1:51
    v_add_f32 v124, v124, v125
    s_waitcnt lgkmcnt(2)
    v_mfma_f32_32x32x16_bf16 v[16:31], a[176:179], a[188:191], v[16:31]
    ds_read_b128 a[208:211], v210 offset:41216
    ds_read_b64_tr_b16 a[196:197], v211 offset:50432
    s_add_u32 m0, m0, 12320
    v_add_f32 v126, v126, v127
    ds_read2st64_b32 v[148:149], v219 offset0:34 offset1:51
    v_mfma_f32_32x32x16_bf16 v[32:47], a[176:179], a[192:195], v[32:47]
    ds_read_b64_tr_b16 a[198:199], v211 offset:51200
    ds_read_b128 a[212:215], v210 offset:45312
    buffer_load_dwordx4 v204, s[44:47], s75 offen offset:0 lds
    s_waitcnt lgkmcnt(15)
    v_add_f32 v128, v128, v129
    v_add_f32 v130, v130, v131
    v_mfma_f32_32x32x16_bf16 v[48:63], a[180:183], a[188:191], v[48:63]
    ds_read_b64_tr_b16 a[200:201], v211 offset:50464
    ds_read_b64_tr_b16 a[202:203], v211 offset:51232
    buffer_load_dwordx4 v205, s[44:47], s75 offen offset:1024 lds
    ds_read2st64_b32 v[150:151], v220 offset0:34 offset1:51
    v_add_f32 v132, v132, v133
    v_mfma_f32_32x32x16_bf16 v[64:79], a[180:183], a[192:195], v[64:79]
    ds_read_b64_tr_b16 a[204:205], v211 offset:50496
    ds_read_b64_tr_b16 a[206:207], v211 offset:51264
    buffer_load_dwordx4 v206, s[44:47], s75 offen offset:2048 lds
    v_cvt_pk_bf16_f32 v160, v118, v120
    ds_read2st64_b32 v[152:153], v221 offset0:34 offset1:51
    v_mfma_f32_32x32x16_bf16 v[80:95], a[184:187], a[188:191], v[80:95]
    s_lshr_b32 s89, s89, 4
    s_and_b32 s73, s89, 7
    v_cvt_pk_bf16_f32 v161, v122, v124
    v_cvt_pk_bf16_f32 v162, v126, v128
    v_mfma_f32_32x32x16_bf16 v[96:111], a[184:187], a[192:195], v[96:111]
    s_lshl_b32 s74, s73, 7
    s_mul_i32 s75, s73, 176128
    ds_read2st64_b32 v[154:155], v222 offset0:34 offset1:51
    v_cvt_pk_bf16_f32 v163, v130, v132
    s_waitcnt lgkmcnt(2)
    v_mfma_f32_32x32x16_bf16 v[16:31], a[196:199], a[208:211], v[16:31]
    s_waitcnt vmcnt(10)
    s_barrier
    s_cmp_lg_u32 s66, 0
    s_cbranch_scc1 L_5
    s_atomic_add s86, s[60:61], s64
L_5:
    v_cvt_pk_bf16_f32 v164, v116, v118
    ds_read2st64_b32 v[156:157], v223 offset0:34 offset1:51
    v_mfma_f32_32x32x16_bf16 v[32:47], a[196:199], a[212:215], v[32:47]
    v_add_u32 v207, 41216, v207
    v_add_u32 v211, 41216, v211
    ds_read_b128 a[188:191], v207 offset:41216
    ds_read_b64_tr_b16 a[176:177], v211 offset:41216
    ds_read_b64_tr_b16 a[178:179], v211 offset:41984
    v_cvt_pk_bf16_f32 v165, v120, v122
    v_cvt_pk_bf16_f32 v166, v124, v126
    v_mfma_f32_32x32x16_bf16 v[48:63], a[200:203], a[208:211], v[48:63]
    ds_read_b128 a[192:195], v207 offset:45312
    ds_read_b64_tr_b16 a[180:181], v211 offset:41248
    ds_read_b64_tr_b16 a[182:183], v211 offset:42016
    ds_read_b64_tr_b16 a[184:185], v211 offset:41280
    ds_read_b64_tr_b16 a[186:187], v211 offset:42048
    v_cvt_pk_bf16_f32 v167, v128, v130
    v_cvt_pk_bf16_f32 v168, v114, v116
    v_mfma_f32_32x32x16_bf16 v[64:79], a[200:203], a[212:215], v[64:79]
    ds_read_u8 v196, v1
    v_add_u32 v208, 41216, v208
    v_add_u32 v209, 41216, v209
    v_cvt_pk_bf16_f32 v169, v118, v120
    v_cvt_pk_bf16_f32 v170, v122, v124
    v_mfma_f32_32x32x16_bf16 v[80:95], a[204:207], a[208:211], v[80:95]
    v_add_u32 v210, 41216, v210
    v_cvt_pk_bf16_f32 v171, v126, v128
    v_cvt_pk_bf16_f32 v172, v112, v114
    v_mfma_f32_32x32x16_bf16 v[96:111], a[204:207], a[212:215], v[96:111]
    v_cvt_pk_bf16_f32 v173, v116, v118
    v_cvt_pk_bf16_f32 v174, v120, v122
    s_waitcnt lgkmcnt(1)
    v_mfma_f32_32x32x16_bf16 v[16:31], a[176:179], a[188:191], v[16:31]
    ds_read_b128 a[208:211], v208 offset:41216
    ds_read_b64_tr_b16 a[196:197], v211 offset:44288
    s_add_u32 m0, s76, 41216
    v_cvt_pk_bf16_f32 v175, v124, v126
    s_waitcnt lgkmcnt(15)
    v_add_f32 v136, v136, v137
    v_mfma_f32_32x32x16_bf16 v[32:47], a[176:179], a[192:195], v[32:47]
    ds_read_b64_tr_b16 a[198:199], v211 offset:45056
    ds_read_b128 a[212:215], v208 offset:45312
    buffer_load_dwordx4 v200, s[36:39], s74 offen offset:0 lds
    v_add_f32 v138, v138, v139
    v_add_f32 v140, v140, v141
    v_mfma_f32_32x32x16_bf16 v[48:63], a[180:183], a[188:191], v[48:63]
    ds_read_b64_tr_b16 a[200:201], v211 offset:44320
    ds_read_b64_tr_b16 a[202:203], v211 offset:45088
    buffer_load_dwordx4 v201, s[36:39], s74 offen offset:1024 lds
    v_add_f32 v142, v142, v143
    s_waitcnt lgkmcnt(15)
    v_add_f32 v144, v144, v145
    v_mfma_f32_32x32x16_bf16 v[64:79], a[180:183], a[192:195], v[64:79]
    ds_read_b64_tr_b16 a[204:205], v211 offset:44352
    ds_read_b64_tr_b16 a[206:207], v211 offset:45120
    buffer_load_dwordx4 v202, s[36:39], s74 offen offset:2048 lds
    v_add_f32 v146, v146, v147
    v_add_f32 v148, v148, v149
    v_mfma_f32_32x32x16_bf16 v[80:95], a[184:187], a[188:191], v[80:95]
    ds_read_u8 v196, v1
    buffer_load_dwordx4 v203, s[36:39], s74 offen offset:3072 lds
    v_add_f32 v150, v150, v151
    s_waitcnt lgkmcnt(15)
    v_add_f32 v152, v152, v153
    v_mfma_f32_32x32x16_bf16 v[96:111], a[184:187], a[192:195], v[96:111]
    v_add_f32 v154, v154, v155
    v_add_f32 v156, v156, v157
    s_waitcnt lgkmcnt(1)
    v_mfma_f32_32x32x16_bf16 v[16:31], a[196:199], a[208:211], v[16:31]
    ds_read_b128 a[188:191], v209 offset:41216
    ds_read_b64_tr_b16 a[176:177], v211 offset:47360
    s_add_u32 m0, s77, 41216
    v_cvt_pk_bf16_f32 v176, v142, v144
    v_cvt_pk_bf16_f32 v177, v146, v148
    v_mfma_f32_32x32x16_bf16 v[32:47], a[196:199], a[212:215], v[32:47]
    ds_read_b64_tr_b16 a[178:179], v211 offset:48128
    ds_read_b128 a[192:195], v209 offset:45312
    buffer_load_dwordx4 v204, s[40:43], s75 offen offset:0 lds
    v_cvt_pk_bf16_f32 v178, v150, v152
    v_cvt_pk_bf16_f32 v179, v154, v156
    v_mfma_f32_32x32x16_bf16 v[48:63], a[200:203], a[208:211], v[48:63]
    ds_read_b64_tr_b16 a[180:181], v211 offset:47392
    ds_read_b64_tr_b16 a[182:183], v211 offset:48160
    buffer_load_dwordx4 v205, s[40:43], s75 offen offset:1024 lds
    v_cvt_pk_bf16_f32 v180, v140, v142
    v_cvt_pk_bf16_f32 v181, v144, v146
    v_mfma_f32_32x32x16_bf16 v[64:79], a[200:203], a[212:215], v[64:79]
    ds_read_b64_tr_b16 a[184:185], v211 offset:47424
    ds_read_b64_tr_b16 a[186:187], v211 offset:48192
    buffer_load_dwordx4 v206, s[40:43], s75 offen offset:2048 lds
    v_cvt_pk_bf16_f32 v182, v148, v150
    v_cvt_pk_bf16_f32 v183, v152, v154
    v_mfma_f32_32x32x16_bf16 v[80:95], a[204:207], a[208:211], v[80:95]
    ds_read_u8 v196, v1
    v_cvt_pk_bf16_f32 v184, v138, v140
    v_cvt_pk_bf16_f32 v185, v142, v144
    v_mfma_f32_32x32x16_bf16 v[96:111], a[204:207], a[212:215], v[96:111]
    v_cvt_pk_bf16_f32 v186, v146, v148
    v_cvt_pk_bf16_f32 v187, v150, v152
    s_waitcnt lgkmcnt(1)
    v_mfma_f32_32x32x16_bf16 v[16:31], a[176:179], a[188:191], v[16:31]
    ds_read_b128 a[208:211], v210 offset:41216
    ds_read_b64_tr_b16 a[196:197], v211 offset:50432
    s_add_u32 m0, m0, 12320
    v_cvt_pk_bf16_f32 v188, v136, v138
    v_cvt_pk_bf16_f32 v189, v140, v142
    v_mfma_f32_32x32x16_bf16 v[32:47], a[176:179], a[192:195], v[32:47]
    ds_read_b64_tr_b16 a[198:199], v211 offset:51200
    ds_read_b128 a[212:215], v210 offset:45312
    buffer_load_dwordx4 v204, s[44:47], s75 offen offset:0 lds
    v_cvt_pk_bf16_f32 v190, v144, v146
    v_cvt_pk_bf16_f32 v191, v148, v150
    v_mfma_f32_32x32x16_bf16 v[48:63], a[180:183], a[188:191], v[48:63]
    ds_read_b64_tr_b16 a[200:201], v211 offset:50464
    ds_read_b64_tr_b16 a[202:203], v211 offset:51232
    buffer_load_dwordx4 v205, s[44:47], s75 offen offset:1024 lds
    v_lshlrev_b32 v9, 2, v8
    v_xor_b32 v9, v9, v1
    v_mfma_f32_32x32x16_bf16 v[64:79], a[180:183], a[192:195], v[64:79]
    ds_read_b64_tr_b16 a[204:205], v211 offset:50496
    ds_read_b64_tr_b16 a[206:207], v211 offset:51264
    buffer_load_dwordx4 v206, s[44:47], s75 offen offset:2048 lds
    v_and_b32 v9, 7, v9
    v_lshlrev_b32 v9, 4, v9
    v_mfma_f32_32x32x16_bf16 v[80:95], a[184:187], a[188:191], v[80:95]
    ds_read_u8 v196, v1
    s_lshr_b32 s89, s89, 4
    s_and_b32 s73, s89, 7
    v_lshrrev_b32 v192, 3, v1
    v_lshl_add_u32 v9, v192, 10, v9
    v_mfma_f32_32x32x16_bf16 v[96:111], a[184:187], a[192:195], v[96:111]
    s_lshl_b32 s74, s73, 7
    s_mul_i32 s75, s73, 176128
    s_lshl_b32 s28, s33, 7
    v_add_u32 v226, s28, v9
    s_waitcnt lgkmcnt(1)
    v_mfma_f32_32x32x16_bf16 v[16:31], a[196:199], a[208:211], v[16:31]
    s_waitcnt vmcnt(10)
    s_barrier
    v_add_u32 v227, 7168, v226
    v_lshl_add_u32 v9, v6, 2, v3
    v_mfma_f32_32x32x16_bf16 v[32:47], a[196:199], a[212:215], v[32:47]
    v_add_u32 v207, -41216, v207
    v_add_u32 v211, -41216, v211
    ds_read_b128 a[188:191], v207 offset:0
    ds_read_b64_tr_b16 a[176:177], v211 offset:0
    ds_read_b64_tr_b16 a[178:179], v211 offset:768
    v_lshlrev_b32 v9, 7, v9
    v_lshrrev_b32 v192, 1, v3
    v_mfma_f32_32x32x16_bf16 v[48:63], a[200:203], a[208:211], v[48:63]
    ds_read_b128 a[192:195], v207 offset:4096
    ds_read_b64_tr_b16 a[180:181], v211 offset:32
    ds_read_b64_tr_b16 a[182:183], v211 offset:800
    ds_read_b64_tr_b16 a[184:185], v211 offset:64
    ds_read_b64_tr_b16 a[186:187], v211 offset:832
    v_xor_b32 v192, s27, v192
    v_lshl_add_u32 v9, v192, 6, v9
    v_mfma_f32_32x32x16_bf16 v[64:79], a[200:203], a[212:215], v[64:79]
    ds_read_u8 v196, v1
    v_add_u32 v208, -41216, v208
    v_add_u32 v209, -41216, v209
    v_lshl_add_u32 v9, v8, 5, v9
    v_lshl_add_u32 v9, v4, 3, v9
    v_mfma_f32_32x32x16_bf16 v[80:95], a[204:207], a[208:211], v[80:95]
    v_add_u32 v210, -41216, v210
    s_mul_i32 s87, s66, 10240
    s_mul_i32 s88, s66, 8192
    v_mfma_f32_32x32x16_bf16 v[96:111], a[204:207], a[212:215], v[96:111]
    s_add_u32 s88, s88, 82432
    v_add_u32 v228, s87, v9
    s_waitcnt lgkmcnt(1)
    v_mfma_f32_32x32x16_bf16 v[16:31], a[176:179], a[188:191], v[16:31]
    ds_read_b128 a[208:211], v208 offset:0
    ds_read_b64_tr_b16 a[196:197], v211 offset:3072
    s_add_u32 m0, s76, 82432
    v_xor_b32 v229, 64, v228
    v_add_u32 v230, s88, v9
    v_mfma_f32_32x32x16_bf16 v[32:47], a[176:179], a[192:195], v[32:47]
    ds_read_b64_tr_b16 a[198:199], v211 offset:3840
    ds_read_b128 a[212:215], v208 offset:4096
    buffer_load_dwordx4 v200, s[36:39], s74 offen offset:0 lds
    v_xor_b32 v231, 64, v230
    s_mul_i32 s28, s66, 22
    v_mfma_f32_32x32x16_bf16 v[48:63], a[180:183], a[188:191], v[48:63]
    ds_read_b64_tr_b16 a[200:201], v211 offset:3104
    ds_read_b64_tr_b16 a[202:203], v211 offset:3872
    buffer_load_dwordx4 v201, s[36:39], s74 offen offset:1024 lds
    s_cmp_eq_u32 s66, 3
    s_cselect_b32 s28, 65, s28
    s_sub_u32 s29, 22, s27
    v_mfma_f32_32x32x16_bf16 v[64:79], a[180:183], a[192:195], v[64:79]
    ds_read_b64_tr_b16 a[204:205], v211 offset:3136
    ds_read_b64_tr_b16 a[206:207], v211 offset:3904
    buffer_load_dwordx4 v202, s[36:39], s74 offen offset:2048 lds
    s_and_b32 s80, s65, 7
    s_mul_i32 s80, s80, 0
    v_mfma_f32_32x32x16_bf16 v[80:95], a[184:187], a[188:191], v[80:95]
    ds_read_u8 v196, v1
    buffer_load_dwordx4 v203, s[36:39], s74 offen offset:3072 lds
    s_lshr_b32 s79, s65, 3
    s_mul_i32 s79, s79, 5
    v_mfma_f32_32x32x16_bf16 v[96:111], a[184:187], a[192:195], v[96:111]
    s_add_u32 s80, s80, s79
    v_add_u32 v9, s80, v1
    s_waitcnt lgkmcnt(1)
    v_mfma_f32_32x32x16_bf16 v[16:31], a[196:199], a[208:211], v[16:31]
    ds_read_b128 a[188:191], v209 offset:0
    ds_read_b64_tr_b16 a[176:177], v211 offset:6144
    s_add_u32 m0, s77, 82432
    v_subrev_u32 v192, s29, v9
    v_min_u32 v9, v9, v192
    v_mfma_f32_32x32x16_bf16 v[32:47], a[196:199], a[212:215], v[32:47]
    ds_read_b64_tr_b16 a[178:179], v211 offset:6912
    ds_read_b128 a[192:195], v209 offset:4096
    buffer_load_dwordx4 v204, s[40:43], s75 offen offset:0 lds
    v_subrev_u32 v192, s29, v9
    v_min_u32 v9, v9, v192
    v_mfma_f32_32x32x16_bf16 v[48:63], a[200:203], a[208:211], v[48:63]
    ds_read_b64_tr_b16 a[180:181], v211 offset:6176
    ds_read_b64_tr_b16 a[182:183], v211 offset:6944
    buffer_load_dwordx4 v205, s[40:43], s75 offen offset:1024 lds
    v_subrev_u32 v192, s29, v9
    v_min_u32 v9, v9, v192
    v_mfma_f32_32x32x16_bf16 v[64:79], a[200:203], a[212:215], v[64:79]
    ds_read_b64_tr_b16 a[184:185], v211 offset:6208
    ds_read_b64_tr_b16 a[186:187], v211 offset:6976
    buffer_load_dwordx4 v206, s[40:43], s75 offen offset:2048 lds
    v_add_u32 v9, s28, v9
    v_lshlrev_b32 v192, 14, v9
    v_mfma_f32_32x32x16_bf16 v[80:95], a[204:207], a[208:211], v[80:95]
    ds_read_u8 v196, v1
    s_nop 0
    v_readlane_b32 s4, v192, 0
    v_mfma_f32_32x32x16_bf16 v[96:111], a[204:207], a[212:215], v[96:111]
    v_readlane_b32 s5, v192, 1
    v_readlane_b32 s6, v192, 2
    s_waitcnt lgkmcnt(1)
    v_mfma_f32_32x32x16_bf16 v[16:31], a[176:179], a[188:191], v[16:31]
    ds_read_b128 a[208:211], v210 offset:0
    ds_read_b64_tr_b16 a[196:197], v211 offset:9216
    s_add_u32 m0, m0, 12320
    v_readlane_b32 s7, v192, 3
    v_readlane_b32 s8, v192, 4
    v_mfma_f32_32x32x16_bf16 v[32:47], a[176:179], a[192:195], v[32:47]
    ds_read_b64_tr_b16 a[198:199], v211 offset:9984
    ds_read_b128 a[212:215], v210 offset:4096
    buffer_load_dwordx4 v204, s[44:47], s75 offen offset:0 lds
    v_readlane_b32 s9, v192, 5
    v_readlane_b32 s10, v192, 6
    v_mfma_f32_32x32x16_bf16 v[48:63], a[180:183], a[188:191], v[48:63]
    ds_read_b64_tr_b16 a[200:201], v211 offset:9248
    ds_read_b64_tr_b16 a[202:203], v211 offset:10016
    buffer_load_dwordx4 v205, s[44:47], s75 offen offset:1024 lds
    v_readlane_b32 s11, v192, 7
    v_readlane_b32 s12, v192, 8
    v_mfma_f32_32x32x16_bf16 v[64:79], a[180:183], a[192:195], v[64:79]
    ds_read_b64_tr_b16 a[204:205], v211 offset:9280
    ds_read_b64_tr_b16 a[206:207], v211 offset:10048
    buffer_load_dwordx4 v206, s[44:47], s75 offen offset:2048 lds
    v_readlane_b32 s13, v192, 9
    v_readlane_b32 s14, v192, 10
    v_mfma_f32_32x32x16_bf16 v[80:95], a[184:187], a[188:191], v[80:95]
    ds_read_u8 v196, v1
    s_lshr_b32 s89, s89, 4
    s_and_b32 s73, s89, 7
    v_readlane_b32 s15, v192, 11
    v_readlane_b32 s16, v192, 12
    v_mfma_f32_32x32x16_bf16 v[96:111], a[184:187], a[192:195], v[96:111]
    s_lshl_b32 s74, s73, 7
    s_mul_i32 s75, s73, 176128
    v_readlane_b32 s17, v192, 13
    v_readlane_b32 s18, v192, 14
    s_waitcnt lgkmcnt(1)
    v_mfma_f32_32x32x16_bf16 v[16:31], a[196:199], a[208:211], v[16:31]
    s_waitcnt vmcnt(10)
    s_barrier
    v_readlane_b32 s19, v192, 15
    v_readlane_b32 s20, v192, 16
    v_mfma_f32_32x32x16_bf16 v[32:47], a[196:199], a[212:215], v[32:47]
    ds_read_b128 a[188:191], v207 offset:41216
    ds_read_b64_tr_b16 a[176:177], v211 offset:41216
    ds_read_b64_tr_b16 a[178:179], v211 offset:41984
    ds_read_b128 a[192:195], v207 offset:45312
    ds_read_b64_tr_b16 a[180:181], v211 offset:41248
    v_readlane_b32 s21, v192, 17
    v_readlane_b32 s22, v192, 18
    v_mfma_f32_32x32x16_bf16 v[48:63], a[200:203], a[208:211], v[48:63]
    ds_read_b64_tr_b16 a[182:183], v211 offset:42016
    ds_read_b64_tr_b16 a[184:185], v211 offset:41280
    ds_read_b64_tr_b16 a[186:187], v211 offset:42048
    ds_read_u8 v196, v1
    v_readlane_b32 s23, v192, 19
    v_readlane_b32 s24, v192, 20
    v_mfma_f32_32x32x16_bf16 v[64:79], a[200:203], a[212:215], v[64:79]
    v_readlane_b32 s25, v192, 21
    s_mul_i32 s28, s27, 16640
    v_mfma_f32_32x32x16_bf16 v[80:95], a[204:207], a[208:211], v[80:95]
    s_lshl_b32 s29, s26, 8
    s_sub_u32 s28, s28, s29
    v_mfma_f32_32x32x16_bf16 v[96:111], a[204:207], a[212:215], v[96:111]
    s_add_u32 s28, s28, 123928
    v_mul_u32_u24 v9, 4160, v4
    s_waitcnt lgkmcnt(1)
    v_mfma_f32_32x32x16_bf16 v[16:31], a[176:179], a[188:191], v[16:31]
    ds_read_b128 a[208:211], v208 offset:41216
    ds_read_b64_tr_b16 a[196:197], v211 offset:44288
    s_mov_b32 m0, s76
    v_lshl_add_u32 v9, v2, 4, v9
    v_lshlrev_b32 v192, 3, v3
    v_mfma_f32_32x32x16_bf16 v[32:47], a[176:179], a[192:195], v[32:47]
    ds_read_b64_tr_b16 a[198:199], v211 offset:45056
    ds_read_b128 a[212:215], v208 offset:45312
    buffer_load_dwordx4 v200, s[36:39], s74 offen offset:0 lds
    v_sub_u32 v9, v9, v192
    v_add_u32 v224, s28, v9
    v_mfma_f32_32x32x16_bf16 v[48:63], a[180:183], a[188:191], v[48:63]
    ds_read_b64_tr_b16 a[200:201], v211 offset:44320
    ds_read_b64_tr_b16 a[202:203], v211 offset:45088
    buffer_load_dwordx4 v201, s[36:39], s74 offen offset:1024 lds
    s_mul_i32 s28, s27, 37888
    s_sub_u32 s28, s28, s29
    v_mfma_f32_32x32x16_bf16 v[64:79], a[180:183], a[192:195], v[64:79]
    ds_read_b64_tr_b16 a[204:205], v211 offset:44352
    ds_read_b64_tr_b16 a[206:207], v211 offset:45120
    buffer_load_dwordx4 v202, s[36:39], s74 offen offset:2048 lds
    s_add_u32 s28, s28, 119296
    v_lshlrev_b32 v9, 4, v2
    v_mfma_f32_32x32x16_bf16 v[80:95], a[184:187], a[188:191], v[80:95]
    ds_read_u8 v196, v1
    buffer_load_dwordx4 v203, s[36:39], s74 offen offset:3072 lds
    v_lshl_add_u32 v9, v7, 5, v9
    v_add_u32 v225, s28, v9
    v_mfma_f32_32x32x16_bf16 v[96:111], a[184:187], a[192:195], v[96:111]
    s_lshl_b32 s28, s32, 1
    s_add_u32 s28, s28, s26
    s_waitcnt lgkmcnt(1)
    v_mfma_f32_32x32x16_bf16 v[16:31], a[196:199], a[208:211], v[16:31]
    ds_read_b128 a[188:191], v209 offset:41216
    ds_read_b64_tr_b16 a[176:177], v211 offset:47360
    s_mov_b32 m0, s77
    s_mul_i32 s29, s28, 88064
    s_add_u32 s29, s29, 4194304
    v_mfma_f32_32x32x16_bf16 v[32:47], a[196:199], a[212:215], v[32:47]
    ds_read_b64_tr_b16 a[178:179], v211 offset:48128
    ds_read_b128 a[192:195], v209 offset:45312
    buffer_load_dwordx4 v204, s[40:43], s75 offen offset:0 lds
    v_lshl_add_u32 v232, v1, 4, s29
    s_xor_b32 s29, s28, 1
    v_mfma_f32_32x32x16_bf16 v[48:63], a[200:203], a[208:211], v[48:63]
    ds_read_b64_tr_b16 a[180:181], v211 offset:47392
    ds_read_b64_tr_b16 a[182:183], v211 offset:48160
    buffer_load_dwordx4 v205, s[40:43], s75 offen offset:1024 lds
    s_mul_i32 s29, s29, 88064
    s_add_u32 s29, s29, 4194304
    v_mfma_f32_32x32x16_bf16 v[64:79], a[200:203], a[212:215], v[64:79]
    ds_read_b64_tr_b16 a[184:185], v211 offset:47424
    ds_read_b64_tr_b16 a[186:187], v211 offset:48192
    buffer_load_dwordx4 v206, s[40:43], s75 offen offset:2048 lds
    v_lshl_add_u32 v233, v1, 4, s29
    s_lshl_b32 s29, s28, 5
    v_mfma_f32_32x32x16_bf16 v[80:95], a[204:207], a[208:211], v[80:95]
    ds_read_u8 v196, v1
    v_add_u32 v9, s29, v5
    v_lshlrev_b32 v192, 3, v9
    v_mfma_f32_32x32x16_bf16 v[96:111], a[204:207], a[212:215], v[96:111]
    v_add_u32 v243, 2097156, v192
    s_lshl_b32 s29, s33, 1
    s_waitcnt lgkmcnt(1)
    v_mfma_f32_32x32x16_bf16 v[16:31], a[176:179], a[188:191], v[16:31]
    ds_read_b128 a[208:211], v210 offset:41216
    ds_read_b64_tr_b16 a[196:197], v211 offset:50432
    s_add_u32 m0, m0, 12320
    s_add_u32 s29, s29, s27
    s_lshl_b32 s31, s29, 6
    v_mfma_f32_32x32x16_bf16 v[32:47], a[176:179], a[192:195], v[32:47]
    ds_read_b64_tr_b16 a[198:199], v211 offset:51200
    ds_read_b128 a[212:215], v210 offset:45312
    buffer_load_dwordx4 v204, s[44:47], s75 offen offset:0 lds
    v_lshlrev_b32 v9, 10, v9
    v_lshl_add_u32 v9, v6, 4, v9
    v_mfma_f32_32x32x16_bf16 v[48:63], a[180:183], a[188:191], v[48:63]
    ds_read_b64_tr_b16 a[200:201], v211 offset:50464
    ds_read_b64_tr_b16 a[202:203], v211 offset:51232
    buffer_load_dwordx4 v205, s[44:47], s75 offen offset:1024 lds
    v_add_u32 v242, s31, v9
    s_lshl_b32 s31, s29, 17
    v_mfma_f32_32x32x16_bf16 v[64:79], a[180:183], a[192:195], v[64:79]
    ds_read_b64_tr_b16 a[204:205], v211 offset:50496
    ds_read_b64_tr_b16 a[206:207], v211 offset:51264
    buffer_load_dwordx4 v206, s[44:47], s75 offen offset:2048 lds
    s_lshl_b32 s28, s28, 6
    s_add_u32 s28, s28, s31
    v_mfma_f32_32x32x16_bf16 v[80:95], a[184:187], a[188:191], v[80:95]
    ds_read_u8 v196, v1
    s_lshr_b32 s89, s89, 4
    s_and_b32 s73, s89, 7
    s_add_u32 s28, s28, 10485760
    v_lshrrev_b32 v9, 2, v1
    v_mfma_f32_32x32x16_bf16 v[96:111], a[184:187], a[192:195], v[96:111]
    s_lshl_b32 s74, s73, 7
    s_mul_i32 s75, s73, 176128
    v_lshlrev_b32 v9, 12, v9
    v_lshl_add_u32 v9, v4, 4, v9
    s_waitcnt lgkmcnt(1)
    v_mfma_f32_32x32x16_bf16 v[16:31], a[196:199], a[208:211], v[16:31]
    s_waitcnt vmcnt(10)
    s_barrier
    v_add_u32 v244, s28, v9
    s_mov_b32 s31, 0x10000
    v_mfma_f32_32x32x16_bf16 v[32:47], a[196:199], a[212:215], v[32:47]
    v_add_u32 v207, 41216, v207
    v_add_u32 v211, 41216, v211
    ds_read_b128 a[188:191], v207 offset:41216
    ds_read_b64_tr_b16 a[176:177], v211 offset:41216
    ds_read_b64_tr_b16 a[178:179], v211 offset:41984
    s_lshl_b32 s28, s66, 11
    s_add_u32 s28, s28, 123648
    v_mfma_f32_32x32x16_bf16 v[48:63], a[200:203], a[208:211], v[48:63]
    ds_read_b128 a[192:195], v207 offset:45312
    ds_read_b64_tr_b16 a[180:181], v211 offset:41248
    ds_read_b64_tr_b16 a[182:183], v211 offset:42016
    ds_read_b64_tr_b16 a[184:185], v211 offset:41280
    ds_read_b64_tr_b16 a[186:187], v211 offset:42048
    v_lshl_add_u32 v245, v1, 4, s28
    v_lshl_add_u32 v9, v6, 2, v3
    v_mfma_f32_32x32x16_bf16 v[64:79], a[200:203], a[212:215], v[64:79]
    v_add_u32 v208, 41216, v208
    v_add_u32 v209, 41216, v209
    v_lshlrev_b32 v9, 6, v9
    v_lshl_add_u32 v9, v8, 5, v9
    v_mfma_f32_32x32x16_bf16 v[80:95], a[204:207], a[208:211], v[80:95]
    v_add_u32 v210, 41216, v210
    v_lshl_add_u32 v9, v4, 3, v9
    v_add_u32 v246, s28, v9
    v_mfma_f32_32x32x16_bf16 v[96:111], a[204:207], a[212:215], v[96:111]
    s_lshl_b32 s29, s29, 11
    s_add_u32 s29, s29, 2195456
    s_waitcnt lgkmcnt(0)
    v_mfma_f32_32x32x16_bf16 v[16:31], a[176:179], a[188:191], v[16:31]
    ds_read_b128 a[208:211], v208 offset:41216
    ds_read_b64_tr_b16 a[196:197], v211 offset:44288
    buffer_load_dword v197, v253, s[60:63], 0 offen sc1
    v_lshl_add_u32 v250, v7, 7, s29
    s_lshr_b32 s28, s32, 1
    v_mfma_f32_32x32x16_bf16 v[32:47], a[176:179], a[192:195], v[32:47]
    ds_read_b64_tr_b16 a[198:199], v211 offset:45056
    ds_read_b128 a[212:215], v208 offset:45312
    s_add_u32 m0, s76, 41216
    s_lshl_b32 s28, s28, 11
    s_add_u32 s28, s28, 2162688
    v_mfma_f32_32x32x16_bf16 v[48:63], a[180:183], a[188:191], v[48:63]
    ds_read_b64_tr_b16 a[200:201], v211 offset:44320
    ds_read_b64_tr_b16 a[202:203], v211 offset:45088
    buffer_load_dwordx4 v200, s[36:39], s74 offen offset:0 lds
    s_mul_i32 s29, s66, 7
    s_lshr_b32 s29, s29, 1
    v_mfma_f32_32x32x16_bf16 v[64:79], a[180:183], a[192:195], v[64:79]
    ds_read_b64_tr_b16 a[204:205], v211 offset:44352
    ds_read_b64_tr_b16 a[206:207], v211 offset:45120
    buffer_load_dwordx4 v201, s[36:39], s74 offen offset:1024 lds
    s_add_u32 s79, s26, 3
    v_min_u32 v9, s79, v7
    v_mfma_f32_32x32x16_bf16 v[80:95], a[184:187], a[188:191], v[80:95]
    buffer_load_dwordx4 v202, s[36:39], s74 offen offset:2048 lds
    buffer_load_dwordx4 v203, s[36:39], s74 offen offset:3072 lds
    v_add_u32 v9, s29, v9
    v_lshl_add_u32 v249, v9, 7, s28
    v_mfma_f32_32x32x16_bf16 v[96:111], a[184:187], a[192:195], v[96:111]
    v_lshlrev_b32 v248, 4, v1
    s_waitcnt lgkmcnt(0)
    v_mfma_f32_32x32x16_bf16 v[16:31], a[196:199], a[208:211], v[16:31]
    ds_read_b128 a[188:191], v209 offset:41216
    ds_read_b64_tr_b16 a[176:177], v211 offset:47360
    s_add_u32 m0, s77, 41216
    v_mfma_f32_32x32x16_bf16 v[32:47], a[196:199], a[212:215], v[32:47]
    ds_read_b64_tr_b16 a[178:179], v211 offset:48128
    ds_read_b128 a[192:195], v209 offset:45312
    buffer_load_dwordx4 v204, s[40:43], s75 offen offset:0 lds
    v_mfma_f32_32x32x16_bf16 v[48:63], a[200:203], a[208:211], v[48:63]
    ds_read_b64_tr_b16 a[180:181], v211 offset:47392
    ds_read_b64_tr_b16 a[182:183], v211 offset:48160
    buffer_load_dwordx4 v205, s[40:43], s75 offen offset:1024 lds
    v_mfma_f32_32x32x16_bf16 v[64:79], a[200:203], a[212:215], v[64:79]
    ds_read_b64_tr_b16 a[184:185], v211 offset:47424
    ds_read_b64_tr_b16 a[186:187], v211 offset:48192
    buffer_load_dwordx4 v206, s[40:43], s75 offen offset:2048 lds
    v_mfma_f32_32x32x16_bf16 v[80:95], a[204:207], a[208:211], v[80:95]
    v_mfma_f32_32x32x16_bf16 v[96:111], a[204:207], a[212:215], v[96:111]
    s_waitcnt lgkmcnt(0)
    v_mfma_f32_32x32x16_bf16 v[16:31], a[176:179], a[188:191], v[16:31]
    ds_read_b128 a[208:211], v210 offset:41216
    ds_read_b64_tr_b16 a[196:197], v211 offset:50432
    s_add_u32 m0, m0, 12320
    v_mfma_f32_32x32x16_bf16 v[32:47], a[176:179], a[192:195], v[32:47]
    ds_read_b64_tr_b16 a[198:199], v211 offset:51200
    ds_read_b128 a[212:215], v210 offset:45312
    buffer_load_dwordx4 v204, s[44:47], s75 offen offset:0 lds
    v_mfma_f32_32x32x16_bf16 v[48:63], a[180:183], a[188:191], v[48:63]
    ds_read_b64_tr_b16 a[200:201], v211 offset:50464
    ds_read_b64_tr_b16 a[202:203], v211 offset:51232
    buffer_load_dwordx4 v205, s[44:47], s75 offen offset:1024 lds
    v_mfma_f32_32x32x16_bf16 v[64:79], a[180:183], a[192:195], v[64:79]
    ds_read_b64_tr_b16 a[204:205], v211 offset:50496
    ds_read_b64_tr_b16 a[206:207], v211 offset:51264
    buffer_load_dwordx4 v206, s[44:47], s75 offen offset:2048 lds
    v_mfma_f32_32x32x16_bf16 v[80:95], a[184:187], a[188:191], v[80:95]
    v_mfma_f32_32x32x16_bf16 v[96:111], a[184:187], a[192:195], v[96:111]
    s_waitcnt lgkmcnt(0)
    v_mfma_f32_32x32x16_bf16 v[16:31], a[196:199], a[208:211], v[16:31]
    s_waitcnt vmcnt(11)
    s_barrier
    v_mfma_f32_32x32x16_bf16 v[32:47], a[196:199], a[212:215], v[32:47]
    v_add_u32 v207, -41216, v207
    v_add_u32 v211, -41216, v211
    ds_read_b128 a[188:191], v207 offset:0
    ds_read_b64_tr_b16 a[176:177], v211 offset:0
    ds_read_b64_tr_b16 a[178:179], v211 offset:768
    v_mfma_f32_32x32x16_bf16 v[48:63], a[200:203], a[208:211], v[48:63]
    ds_read_b128 a[192:195], v207 offset:4096
    ds_read_b64_tr_b16 a[180:181], v211 offset:32
    ds_read_b64_tr_b16 a[182:183], v211 offset:800
    ds_read_b64_tr_b16 a[184:185], v211 offset:64
    ds_read_b64_tr_b16 a[186:187], v211 offset:832
    v_mfma_f32_32x32x16_bf16 v[64:79], a[200:203], a[212:215], v[64:79]
    v_add_u32 v208, -41216, v208
    v_add_u32 v209, -41216, v209
    v_mfma_f32_32x32x16_bf16 v[80:95], a[204:207], a[208:211], v[80:95]
    v_add_u32 v210, -41216, v210
    s_waitcnt vmcnt(10)
    v_cmp_gt_u32 vcc, 64, v197
    s_cbranch_vccnz RT_7
OK_6:
    v_mfma_f32_32x32x16_bf16 v[96:111], a[204:207], a[212:215], v[96:111]
    buffer_load_dword a150, v240, s[52:55], 0 offen offset:0 sc1
    buffer_load_dword a152, v240, s[52:55], 0 offen offset:256 sc1
    buffer_load_dword a144, v241, s[52:55], 0 offen offset:0 sc1
    buffer_load_dword a146, v241, s[52:55], 0 offen offset:128 sc1
    buffer_load_dword a148, v241, s[52:55], 0 offen offset:256 sc1
    buffer_load_dwordx4 a[156:159], v237, s[52:55], 0 offen sc1
    buffer_load_dwordx4 a[160:163], v237, s[52:55], s30 offen sc1
    s_waitcnt lgkmcnt(0)
    v_mfma_f32_32x32x16_bf16 v[16:31], a[176:179], a[188:191], v[16:31]
    ds_read_b128 a[208:211], v208 offset:0
    ds_read_b64_tr_b16 a[196:197], v211 offset:3072
    ds_write_b128 v212, v[160:163] offset:0
    v_mfma_f32_32x32x16_bf16 v[32:47], a[176:179], a[192:195], v[32:47]
    ds_read_b64_tr_b16 a[198:199], v211 offset:3840
    ds_read_b128 a[212:215], v208 offset:4096
    ds_write_b128 v212, v[164:167] offset:4160
    v_mfma_f32_32x32x16_bf16 v[48:63], a[180:183], a[188:191], v[48:63]
    ds_read_b64_tr_b16 a[200:201], v211 offset:3104
    ds_read_b64_tr_b16 a[202:203], v211 offset:3872
    ds_write_b128 v212, v[168:171] offset:8320
    v_mfma_f32_32x32x16_bf16 v[64:79], a[180:183], a[192:195], v[64:79]
    ds_read_b64_tr_b16 a[204:205], v211 offset:3136
    ds_read_b64_tr_b16 a[206:207], v211 offset:3904
    v_mfma_f32_32x32x16_bf16 v[80:95], a[184:187], a[188:191], v[80:95]
    v_mfma_f32_32x32x16_bf16 v[96:111], a[184:187], a[192:195], v[96:111]
    s_waitcnt lgkmcnt(0)
    v_mfma_f32_32x32x16_bf16 v[16:31], a[196:199], a[208:211], v[16:31]
    ds_read_b128 a[188:191], v209 offset:0
    ds_read_b64_tr_b16 a[176:177], v211 offset:6144
    ds_write_b128 v212, v[172:175] offset:12480
    v_mfma_f32_32x32x16_bf16 v[32:47], a[196:199], a[212:215], v[32:47]
    ds_read_b64_tr_b16 a[178:179], v211 offset:6912
    ds_read_b128 a[192:195], v209 offset:4096
    ds_write_b128 v212, v[176:179] offset:16640
    v_mfma_f32_32x32x16_bf16 v[48:63], a[200:203], a[208:211], v[48:63]
    ds_read_b64_tr_b16 a[180:181], v211 offset:6176
    ds_read_b64_tr_b16 a[182:183], v211 offset:6944
    ds_write_b128 v212, v[180:183] offset:20800
    v_mfma_f32_32x32x16_bf16 v[64:79], a[200:203], a[212:215], v[64:79]
    ds_read_b64_tr_b16 a[184:185], v211 offset:6208
    ds_read_b64_tr_b16 a[186:187], v211 offset:6976
    v_mfma_f32_32x32x16_bf16 v[80:95], a[204:207], a[208:211], v[80:95]
    v_mfma_f32_32x32x16_bf16 v[96:111], a[204:207], a[212:215], v[96:111]
    s_waitcnt lgkmcnt(0)
    v_mfma_f32_32x32x16_bf16 v[16:31], a[176:179], a[188:191], v[16:31]
    ds_read_b128 a[208:211], v210 offset:0
    ds_read_b64_tr_b16 a[196:197], v211 offset:9216
    s_mov_b32 m0, s88
    v_mfma_f32_32x32x16_bf16 v[32:47], a[176:179], a[192:195], v[32:47]
    ds_read_b64_tr_b16 a[198:199], v211 offset:9984
    ds_read_b128 a[212:215], v210 offset:4096
    buffer_load_dwordx4 v226, s[48:51], s4 offen offset:0 lds
    v_mfma_f32_32x32x16_bf16 v[48:63], a[180:183], a[188:191], v[48:63]
    ds_read_b64_tr_b16 a[200:201], v211 offset:9248
    ds_read_b64_tr_b16 a[202:203], v211 offset:10016
    buffer_load_dwordx4 v227, s[48:51], s4 offen offset:1024 lds
    v_mfma_f32_32x32x16_bf16 v[64:79], a[180:183], a[192:195], v[64:79]
    ds_read_b64_tr_b16 a[204:205], v211 offset:9280
    ds_read_b64_tr_b16 a[206:207], v211 offset:10048
    s_add_u32 m0, s88, 2048
    v_mfma_f32_32x32x16_bf16 v[80:95], a[184:187], a[188:191], v[80:95]
    buffer_load_dwordx4 v226, s[48:51], s5 offen offset:0 lds
    buffer_load_dwordx4 v227, s[48:51], s5 offen offset:1024 lds
    v_mfma_f32_32x32x16_bf16 v[96:111], a[184:187], a[192:195], v[96:111]
    s_add_u32 m0, s88, 4096
    s_nop 0
    buffer_load_dwordx4 v226, s[48:51], s6 offen offset:0 lds
    buffer_load_dwordx4 v227, s[48:51], s6 offen offset:1024 lds
    s_waitcnt lgkmcnt(0)
    v_mfma_f32_32x32x16_bf16 v[16:31], a[196:199], a[208:211], v[16:31]
    s_waitcnt vmcnt(13)
    s_barrier
    v_mfma_f32_32x32x16_bf16 v[32:47], a[196:199], a[212:215], v[32:47]
    ds_read_b128 a[188:191], v207 offset:41216
    ds_read_b64_tr_b16 a[176:177], v211 offset:41216
    ds_read_b64_tr_b16 a[178:179], v211 offset:41984
    ds_read_b128 a[192:195], v207 offset:45312
    ds_read_b64_tr_b16 a[180:181], v211 offset:41248
    v_mfma_f32_32x32x16_bf16 v[48:63], a[200:203], a[208:211], v[48:63]
    ds_read_b64_tr_b16 a[182:183], v211 offset:42016
    ds_read_b64_tr_b16 a[184:185], v211 offset:41280
    ds_read_b64_tr_b16 a[186:187], v211 offset:42048
    v_mfma_f32_32x32x16_bf16 v[64:79], a[200:203], a[212:215], v[64:79]
    v_mfma_f32_32x32x16_bf16 v[80:95], a[204:207], a[208:211], v[80:95]
    v_mfma_f32_32x32x16_bf16 v[96:111], a[204:207], a[212:215], v[96:111]
    s_waitcnt lgkmcnt(0)
    v_mfma_f32_32x32x16_bf16 v[16:31], a[176:179], a[188:191], v[16:31]
    ds_read_b128 a[208:211], v208 offset:41216
    ds_read_b128 a[228:231], v209 offset:41216
    ds_read_b128 a[248:251], v210 offset:41216
    ds_read_b64_tr_b16 a[196:197], v211 offset:44288
    v_mfma_f32_32x32x16_bf16 v[32:47], a[176:179], a[192:195], v[32:47]
    ds_read_b64_tr_b16 a[198:199], v211 offset:45056
    ds_read_b64_tr_b16 a[216:217], v211 offset:47360
    ds_read_b64_tr_b16 a[218:219], v211 offset:48128
    ds_read_b64_tr_b16 a[236:237], v211 offset:50432
    v_mfma_f32_32x32x16_bf16 v[48:63], a[180:183], a[188:191], v[48:63]
    ds_read_b64_tr_b16 a[238:239], v211 offset:51200
    ds_read_b128 a[212:215], v208 offset:45312
    ds_read_b128 a[232:235], v209 offset:45312
    ds_read_b128 a[252:255], v210 offset:45312
    v_mfma_f32_32x32x16_bf16 v[64:79], a[180:183], a[192:195], v[64:79]
    ds_read_b64_tr_b16 a[200:201], v211 offset:44320
    ds_read_b64_tr_b16 a[202:203], v211 offset:45088
    ds_read_b64_tr_b16 a[220:221], v211 offset:47392
    ds_read_b64_tr_b16 a[222:223], v211 offset:48160
    v_mfma_f32_32x32x16_bf16 v[80:95], a[184:187], a[188:191], v[80:95]
    ds_read_b64_tr_b16 a[240:241], v211 offset:50464
    ds_read_b64_tr_b16 a[242:243], v211 offset:51232
    s_waitcnt vmcnt(8)
    v_accvgpr_read_b32 v9, a144
    v_accvgpr_read_b32 v10, a146
    v_accvgpr_read_b32 v11, a148
    v_max3_u32 v9, v9, v10, v11
    v_cmp_eq_u32 vcc, -1, v9
    s_cbranch_vccnz RT_10
OK_9:
    v_mfma_f32_32x32x16_bf16 v[96:111], a[184:187], a[192:195], v[96:111]
    v_mfma_f32_32x32x8_bf16 v[16:31], a[144:145], a[150:151], v[16:31]
    ds_read_b64_tr_b16 a[204:205], v211 offset:44352
    ds_read_b64_tr_b16 a[206:207], v211 offset:45120
    ds_read_b64_tr_b16 a[224:225], v211 offset:47424
    ds_read_b64_tr_b16 a[226:227], v211 offset:48192
    v_mfma_f32_32x32x8_bf16 v[32:47], a[144:145], a[152:153], v[32:47]
    ds_read_b64_tr_b16 a[244:245], v211 offset:50496
    ds_read_b64_tr_b16 a[246:247], v211 offset:51264
    v_mfma_f32_32x32x8_bf16 v[48:63], a[146:147], a[150:151], v[48:63]
    ds_write_b128 v239, a[164:167]
    v_mfma_f32_32x32x8_bf16 v[64:79], a[146:147], a[152:153], v[64:79]
    s_waitcnt vmcnt(6)
    ds_write_b128 v238, a[156:159] offset:0
    v_mfma_f32_32x32x8_bf16 v[80:95], a[148:149], a[150:151], v[80:95]
    s_waitcnt vmcnt(6)
    ds_write_b128 v238, a[160:163] offset:2048
    v_mfma_f32_32x32x8_bf16 v[96:111], a[148:149], a[152:153], v[96:111]
    ds_write_b128 v212, v[184:187] offset:24960
    s_waitcnt lgkmcnt(15)
    v_mfma_f32_32x32x16_bf16 v[16:31], a[196:199], a[208:211], v[16:31]
    v_mfma_f32_32x32x16_bf16 v[16:31], a[216:219], a[228:231], v[16:31]
    ds_write_b128 v212, v[188:191] offset:29120
    v_mfma_f32_32x32x16_bf16 v[16:31], a[236:239], a[248:251], v[16:31]
    s_waitcnt lgkmcnt(15)
    v_mfma_f32_32x32x16_bf16 v[32:47], a[196:199], a[212:215], v[32:47]
    ds_write_b128 v254, a[164:167]
    v_mfma_f32_32x32x16_bf16 v[32:47], a[216:219], a[232:235], v[32:47]
    v_mfma_f32_32x32x16_bf16 v[32:47], a[236:239], a[252:255], v[32:47]
    s_waitcnt lgkmcnt(12)
    v_mfma_f32_32x32x16_bf16 v[48:63], a[200:203], a[208:211], v[48:63]
    v_mfma_f32_32x32x16_bf16 v[48:63], a[220:223], a[228:231], v[48:63]
    v_mfma_f32_32x32x16_bf16 v[48:63], a[240:243], a[248:251], v[48:63]
    v_mfma_f32_32x32x16_bf16 v[64:79], a[200:203], a[212:215], v[64:79]
    v_mfma_f32_32x32x16_bf16 v[64:79], a[220:223], a[232:235], v[64:79]
    v_mfma_f32_32x32x16_bf16 v[64:79], a[240:243], a[252:255], v[64:79]
    v_mul_f32 v16, v16, v24
    v_mul_f32 v17, v17, v25
    v_mul_f32 v18, v18, v26
    v_mul_f32 v19, v19, v27
    s_waitcnt lgkmcnt(6)
    v_mfma_f32_32x32x16_bf16 v[80:95], a[204:207], a[208:211], v[80:95]
    v_mul_f32 v20, v20, v28
    v_mul_f32 v21, v21, v29
    v_mul_f32 v22, v22, v30
    v_mul_f32 v23, v23, v31
    v_mfma_f32_32x32x16_bf16 v[80:95], a[224:227], a[228:231], v[80:95]
    v_cvt_pk_bf16_f32 v24, v16, v17
    v_cvt_pk_bf16_f32 v25, v18, v19
    v_cvt_pk_bf16_f32 v26, v20, v21
    v_cvt_pk_bf16_f32 v27, v22, v23
    v_mfma_f32_32x32x16_bf16 v[80:95], a[244:247], a[248:251], v[80:95]
    buffer_store_dwordx4 v[24:27], v234, s[52:55], s83 offen sc1
    v_mul_f32 v32, v32, v40
    v_mul_f32 v33, v33, v41
    v_mul_f32 v34, v34, v42
    v_mfma_f32_32x32x16_bf16 v[96:111], a[204:207], a[212:215], v[96:111]
    v_mul_f32 v35, v35, v43
    v_mul_f32 v36, v36, v44
    v_mul_f32 v37, v37, v45
    v_mul_f32 v38, v38, v46
    v_mfma_f32_32x32x16_bf16 v[96:111], a[224:227], a[232:235], v[96:111]
    v_mul_f32 v39, v39, v47
    v_cvt_pk_bf16_f32 v40, v32, v33
    v_cvt_pk_bf16_f32 v41, v34, v35
    v_cvt_pk_bf16_f32 v42, v36, v37
    v_mfma_f32_32x32x16_bf16 v[96:111], a[244:247], a[252:255], v[96:111]
    v_cvt_pk_bf16_f32 v43, v38, v39
    buffer_store_dwordx4 v[40:43], v234, s[52:55], s84 offen sc1
    v_mul_f32 v48, v48, v56
    v_mul_f32 v49, v49, v57
    v_mul_f32 v50, v50, v58
    v_mul_f32 v51, v51, v59
    v_mul_f32 v52, v52, v60
    v_mul_f32 v53, v53, v61
    v_mul_f32 v54, v54, v62
    v_mul_f32 v55, v55, v63
    v_cvt_pk_bf16_f32 v56, v48, v49
    v_cvt_pk_bf16_f32 v57, v50, v51
    v_cvt_pk_bf16_f32 v58, v52, v53
    v_cvt_pk_bf16_f32 v59, v54, v55
    buffer_store_dwordx4 v[56:59], v235, s[52:55], s83 offen sc1
    v_mul_f32 v64, v64, v72
    v_mul_f32 v65, v65, v73
    v_mul_f32 v66, v66, v74
    v_mul_f32 v67, v67, v75
    v_mul_f32 v68, v68, v76
    v_mul_f32 v69, v69, v77
    v_mul_f32 v70, v70, v78
    v_mul_f32 v71, v71, v79
    v_cvt_pk_bf16_f32 v72, v64, v65
    v_cvt_pk_bf16_f32 v73, v66, v67
    v_cvt_pk_bf16_f32 v74, v68, v69
    v_cvt_pk_bf16_f32 v75, v70, v71
    buffer_store_dwordx4 v[72:75], v235, s[52:55], s84 offen sc1
    v_mul_f32 v80, v80, v88
    v_mul_f32 v81, v81, v89
    v_mul_f32 v82, v82, v90
    v_mul_f32 v83, v83, v91
    v_mul_f32 v84, v84, v92
    v_mul_f32 v85, v85, v93
    v_mul_f32 v86, v86, v94
    v_mul_f32 v87, v87, v95
    v_cvt_pk_bf16_f32 v88, v80, v81
    v_cvt_pk_bf16_f32 v89, v82, v83
    v_cvt_pk_bf16_f32 v90, v84, v85
    v_cvt_pk_bf16_f32 v91, v86, v87
    buffer_store_dwordx4 v[88:91], v236, s[52:55], s83 offen sc1
    v_mul_f32 v96, v96, v104
    v_mul_f32 v97, v97, v105
    v_mul_f32 v98, v98, v106
    v_mul_f32 v99, v99, v107
    v_mul_f32 v100, v100, v108
    v_mul_f32 v101, v101, v109
    v_mul_f32 v102, v102, v110
    v_mul_f32 v103, v103, v111
    v_cvt_pk_bf16_f32 v104, v96, v97
    v_cvt_pk_bf16_f32 v105, v98, v99
    v_cvt_pk_bf16_f32 v106, v100, v101
    v_cvt_pk_bf16_f32 v107, v102, v103
    buffer_store_dwordx4 v[104:107], v236, s[52:55], s84 offen sc1
MRG_4:
    s_waitcnt lgkmcnt(0)
    s_barrier
    ds_read_b128 a[208:211], v225 offset:192
    ds_read_b64 a[176:177], v224 offset:3776
    ds_read_b64 a[178:179], v224 offset:3784
    ds_read_b128 a[212:215], v225 offset:704
    ds_read_b64 a[180:181], v224 offset:3264
    ds_read_b64 a[182:183], v224 offset:3272
    ds_read_b128 a[216:219], v225 offset:1216
    ds_read_b64 a[184:185], v224 offset:2752
    ds_read_b64 a[186:187], v224 offset:2760
    ds_read_b128 a[220:223], v225 offset:1728
    ds_read_b64 a[188:189], v224 offset:2240
    ds_read_b64 a[190:191], v224 offset:2248
    ds_read_b128 a[224:227], v225 offset:2240
    ds_read_b64 a[192:193], v224 offset:1728
    ds_read_b64 a[194:195], v224 offset:1736
    s_waitcnt lgkmcnt(12)
    v_mfma_f32_16x16x32_bf16 v[112:115], a[176:179], a[208:211], 0
    ds_read_b128 a[228:231], v225 offset:2752
    ds_read_b64 a[196:197], v224 offset:1216
    ds_read_b64 a[198:199], v224 offset:1224
    s_waitcnt lgkmcnt(12)
    v_mfma_f32_16x16x32_bf16 v[116:119], a[176:179], a[212:215], 0
    ds_read_b128 a[232:235], v225 offset:3264
    ds_read_b64 a[200:201], v224 offset:704
    ds_read_b64 a[202:203], v224 offset:712
    v_mfma_f32_16x16x32_bf16 v[116:119], a[180:183], a[208:211], v[116:119]
    ds_read_b128 a[236:239], v225 offset:3776
    ds_read_b64 a[204:205], v224 offset:192
    ds_read_b64 a[206:207], v224 offset:200
    s_waitcnt lgkmcnt(15)
    v_mfma_f32_16x16x32_bf16 v[120:123], a[176:179], a[216:219], 0
    ds_read_b128 v[48:51], v225 offset:128
    ds_read_b64 v[16:17], v224 offset:3712
    ds_read_b64 v[18:19], v224 offset:3720
    v_mfma_f32_16x16x32_bf16 v[120:123], a[180:183], a[212:215], v[120:123]
    ds_read_b128 v[52:55], v225 offset:640
    ds_read_b64 v[20:21], v224 offset:3200
    v_mfma_f32_16x16x32_bf16 v[120:123], a[184:187], a[208:211], v[120:123]
    ds_read_b64 v[22:23], v224 offset:3208
    ds_read_b128 v[56:59], v225 offset:1152
    s_waitcnt lgkmcnt(15)
    v_mfma_f32_16x16x32_bf16 v[124:127], a[176:179], a[220:223], 0
    ds_read_b64 v[24:25], v224 offset:2688
    ds_read_b64 v[26:27], v224 offset:2696
    v_mfma_f32_16x16x32_bf16 v[124:127], a[180:183], a[216:219], v[124:127]
    ds_read_b128 v[60:63], v225 offset:1664
    ds_read_b64 v[28:29], v224 offset:2176
    v_mfma_f32_16x16x32_bf16 v[124:127], a[184:187], a[212:215], v[124:127]
    ds_read_b64 v[30:31], v224 offset:2184
    ds_read_b128 v[64:67], v225 offset:2176
    v_mfma_f32_16x16x32_bf16 v[124:127], a[188:191], a[208:211], v[124:127]
    ds_read_b64 v[32:33], v224 offset:1664
    ds_read_b64 v[34:35], v224 offset:1672
    s_waitcnt lgkmcnt(15)
    v_mfma_f32_16x16x32_bf16 v[128:131], a[176:179], a[224:227], 0
    ds_read_b128 v[68:71], v225 offset:2688
    ds_read_b64 v[36:37], v224 offset:1152
    v_mfma_f32_16x16x32_bf16 v[128:131], a[180:183], a[220:223], v[128:131]
    ds_read_b64 v[38:39], v224 offset:1160
    ds_read_b128 v[72:75], v225 offset:3200
    v_mfma_f32_16x16x32_bf16 v[128:131], a[184:187], a[216:219], v[128:131]
    ds_read_b64 v[40:41], v224 offset:640
    ds_read_b64 v[42:43], v224 offset:648
    v_mfma_f32_16x16x32_bf16 v[128:131], a[188:191], a[212:215], v[128:131]
    ds_read_b128 v[76:79], v225 offset:3712
    ds_read_b64 v[44:45], v224 offset:128
    v_mfma_f32_16x16x32_bf16 v[128:131], a[192:195], a[208:211], v[128:131]
    ds_read_b64 v[46:47], v224 offset:136
    s_add_u32 m0, s88, 6144
    s_waitcnt lgkmcnt(15)
    v_mfma_f32_16x16x32_bf16 v[132:135], a[176:179], a[228:231], 0
    buffer_load_dwordx4 v226, s[48:51], s7 offen offset:0 lds
    buffer_load_dwordx4 v227, s[48:51], s7 offen offset:1024 lds
    v_mfma_f32_16x16x32_bf16 v[132:135], a[180:183], a[224:227], v[132:135]
    s_mov_b32 m0, s87
    s_nop 0
    buffer_load_dwordx4 v226, s[48:51], s8 offen offset:0 lds
    v_mfma_f32_16x16x32_bf16 v[132:135], a[184:187], a[220:223], v[132:135]
    buffer_load_dwordx4 v227, s[48:51], s8 offen offset:1024 lds
    s_add_u32 m0, s87, 2048
    v_mfma_f32_16x16x32_bf16 v[132:135], a[188:191], a[216:219], v[132:135]
    buffer_load_dwordx4 v226, s[48:51], s9 offen offset:0 lds
    buffer_load_dwordx4 v227, s[48:51], s9 offen offset:1024 lds
    v_mfma_f32_16x16x32_bf16 v[132:135], a[192:195], a[212:215], v[132:135]
    v_mfma_f32_16x16x32_bf16 v[132:135], a[196:199], a[208:211], v[132:135]
    s_waitcnt vmcnt(16)
    ds_read_b64_tr_b16 a[0:1], v230 offset:0
    ds_read_b64_tr_b16 a[2:3], v230 offset:1024
    s_waitcnt lgkmcnt(15)
    v_mfma_f32_16x16x32_bf16 v[136:139], a[176:179], a[232:235], 0
    ds_read_b64_tr_b16 a[4:5], v231 offset:0
    ds_read_b64_tr_b16 a[6:7], v231 offset:1024
    v_mfma_f32_16x16x32_bf16 v[136:139], a[180:183], a[228:231], v[136:139]
    s_waitcnt vmcnt(14)
    ds_read_b64_tr_b16 a[8:9], v230 offset:2048
    ds_read_b64_tr_b16 a[10:11], v230 offset:3072
    v_mfma_f32_16x16x32_bf16 v[136:139], a[184:187], a[224:227], v[136:139]
    ds_read_b64_tr_b16 a[12:13], v231 offset:2048
    ds_read_b64_tr_b16 a[14:15], v231 offset:3072
    v_mfma_f32_16x16x32_bf16 v[136:139], a[188:191], a[220:223], v[136:139]
    s_waitcnt vmcnt(12)
    ds_read_b64_tr_b16 a[16:17], v230 offset:4096
    ds_read_b64_tr_b16 a[18:19], v230 offset:5120
    v_mfma_f32_16x16x32_bf16 v[136:139], a[192:195], a[216:219], v[136:139]
    ds_read_b64_tr_b16 a[20:21], v231 offset:4096
    ds_read_b64_tr_b16 a[22:23], v231 offset:5120
    v_mfma_f32_16x16x32_bf16 v[136:139], a[196:199], a[212:215], v[136:139]
    v_mfma_f32_16x16x32_bf16 v[136:139], a[200:203], a[208:211], v[136:139]
    s_waitcnt lgkmcnt(15)
    v_mfma_f32_16x16x32_bf16 v[140:143], a[176:179], a[236:239], 0
    v_mfma_f32_16x16x32_bf16 v[140:143], a[180:183], a[232:235], v[140:143]
    v_mfma_f32_16x16x32_bf16 v[140:143], a[184:187], a[228:231], v[140:143]
    v_mfma_f32_16x16x32_bf16 v[140:143], a[188:191], a[224:227], v[140:143]
    v_mfma_f32_16x16x32_bf16 v[140:143], a[192:195], a[220:223], v[140:143]
    v_mfma_f32_16x16x32_bf16 v[140:143], a[196:199], a[216:219], v[140:143]
    v_mfma_f32_16x16x32_bf16 v[140:143], a[200:203], a[212:215], v[140:143]
    v_mfma_f32_16x16x32_bf16 v[140:143], a[204:207], a[208:211], v[140:143]
    s_waitcnt lgkmcnt(12)
    v_mfma_f32_16x16x32_bf16 v[112:115], v[16:19], v[48:51], v[112:115]
    ds_read_b128 a[208:211], v225 offset:64
    ds_read_b64 a[176:177], v224 offset:3648
    v_mfma_f32_16x16x32_bf16 v[116:119], v[16:19], v[52:55], v[116:119]
    ds_read_b64 a[178:179], v224 offset:3656
    ds_read_b128 a[212:215], v225 offset:576
    v_mfma_f32_16x16x32_bf16 v[116:119], v[20:23], v[48:51], v[116:119]
    ds_read_b64 a[180:181], v224 offset:3136
    ds_read_b64 a[182:183], v224 offset:3144
    v_mfma_f32_16x16x32_bf16 v[120:123], v[16:19], v[56:59], v[120:123]
    ds_read_b128 a[216:219], v225 offset:1088
    ds_read_b64 a[184:185], v224 offset:2624
    v_mfma_f32_16x16x32_bf16 v[120:123], v[20:23], v[52:55], v[120:123]
    ds_read_b64 a[186:187], v224 offset:2632
    ds_read_b128 a[220:223], v225 offset:1600
    v_mfma_f32_16x16x32_bf16 v[120:123], v[24:27], v[48:51], v[120:123]
    ds_read_b64 a[188:189], v224 offset:2112
    ds_read_b64 a[190:191], v224 offset:2120
    v_mfma_f32_16x16x32_bf16 v[124:127], v[16:19], v[60:63], v[124:127]
    ds_read_b128 a[224:227], v225 offset:2112
    ds_read_b64 a[192:193], v224 offset:1600
    v_mfma_f32_16x16x32_bf16 v[124:127], v[20:23], v[56:59], v[124:127]
    ds_read_b64 a[194:195], v224 offset:1608
    ds_read_b128 a[228:231], v225 offset:2624
    v_mfma_f32_16x16x32_bf16 v[124:127], v[24:27], v[52:55], v[124:127]
    ds_read_b64 a[196:197], v224 offset:1088
    ds_read_b64 a[198:199], v224 offset:1096
    v_mfma_f32_16x16x32_bf16 v[124:127], v[28:31], v[48:51], v[124:127]
    ds_read_b128 a[232:235], v225 offset:3136
    ds_read_b64 a[200:201], v224 offset:576
    v_mfma_f32_16x16x32_bf16 v[128:131], v[16:19], v[64:67], v[128:131]
    ds_read_b64 a[202:203], v224 offset:584
    ds_read_b128 a[236:239], v225 offset:3648
    v_mfma_f32_16x16x32_bf16 v[128:131], v[20:23], v[60:63], v[128:131]
    ds_read_b64 a[204:205], v224 offset:64
    ds_read_b64 a[206:207], v224 offset:72
    v_mfma_f32_16x16x32_bf16 v[128:131], v[24:27], v[56:59], v[128:131]
    v_mfma_f32_16x16x32_bf16 v[128:131], v[28:31], v[52:55], v[128:131]
    v_mfma_f32_16x16x32_bf16 v[128:131], v[32:35], v[48:51], v[128:131]
    v_mfma_f32_16x16x32_bf16 v[132:135], v[16:19], v[68:71], v[132:135]
    v_mfma_f32_16x16x32_bf16 v[132:135], v[20:23], v[64:67], v[132:135]
    v_mfma_f32_16x16x32_bf16 v[132:135], v[24:27], v[60:63], v[132:135]
    v_mfma_f32_16x16x32_bf16 v[132:135], v[28:31], v[56:59], v[132:135]
    v_mfma_f32_16x16x32_bf16 v[132:135], v[32:35], v[52:55], v[132:135]
    v_mfma_f32_16x16x32_bf16 v[132:135], v[36:39], v[48:51], v[132:135]
    v_mfma_f32_16x16x32_bf16 v[136:139], v[16:19], v[72:75], v[136:139]
    v_mfma_f32_16x16x32_bf16 v[136:139], v[20:23], v[68:71], v[136:139]
    v_mfma_f32_16x16x32_bf16 v[136:139], v[24:27], v[64:67], v[136:139]
    v_mfma_f32_16x16x32_bf16 v[136:139], v[28:31], v[60:63], v[136:139]
    v_mfma_f32_16x16x32_bf16 v[136:139], v[32:35], v[56:59], v[136:139]
    v_mfma_f32_16x16x32_bf16 v[136:139], v[36:39], v[52:55], v[136:139]
    v_mfma_f32_16x16x32_bf16 v[136:139], v[40:43], v[48:51], v[136:139]
    v_mfma_f32_16x16x32_bf16 v[140:143], v[16:19], v[76:79], v[140:143]
    v_mfma_f32_16x16x32_bf16 v[140:143], v[20:23], v[72:75], v[140:143]
    v_mfma_f32_16x16x32_bf16 v[140:143], v[24:27], v[68:71], v[140:143]
    s_waitcnt vmcnt(6)
    s_atomic_add s86, s[52:53], s94
    v_mfma_f32_16x16x32_bf16 v[140:143], v[28:31], v[64:67], v[140:143]
    s_add_u32 m0, s87, 4096
    s_nop 0
    buffer_load_dwordx4 v226, s[48:51], s10 offen offset:0 lds
    v_mfma_f32_16x16x32_bf16 v[140:143], v[32:35], v[60:63], v[140:143]
    buffer_load_dwordx4 v227, s[48:51], s10 offen offset:1024 lds
    v_mfma_f32_16x16x32_bf16 v[140:143], v[36:39], v[56:59], v[140:143]
    s_add_u32 m0, s87, 6144
    s_nop 0
    buffer_load_dwordx4 v226, s[48:51], s11 offen offset:0 lds
    v_mfma_f32_16x16x32_bf16 v[140:143], v[40:43], v[52:55], v[140:143]
    buffer_load_dwordx4 v227, s[48:51], s11 offen offset:1024 lds
    v_mfma_f32_16x16x32_bf16 v[140:143], v[44:47], v[48:51], v[140:143]
    ds_read_u8 v196, v1
    s_waitcnt lgkmcnt(1)
    v_mfma_f32_16x16x32_bf16 v[112:115], a[176:179], a[208:211], v[112:115]
    s_add_u32 m0, s87, 8192
    s_nop 0
    buffer_load_dwordx4 v226, s[48:51], s12 offen offset:0 lds
    v_mfma_f32_16x16x32_bf16 v[116:119], a[176:179], a[212:215], v[116:119]
    ds_read_b128 v[48:51], v225 offset:0
    ds_read_b64 v[16:17], v224 offset:3584
    v_mfma_f32_16x16x32_bf16 v[116:119], a[180:183], a[208:211], v[116:119]
    ds_read_b64 v[18:19], v224 offset:3592
    ds_read_b128 v[52:55], v225 offset:512
    v_mfma_f32_16x16x32_bf16 v[120:123], a[176:179], a[216:219], v[120:123]
    ds_read_b64 v[20:21], v224 offset:3072
    ds_read_b64 v[22:23], v224 offset:3080
    v_mfma_f32_16x16x32_bf16 v[120:123], a[180:183], a[212:215], v[120:123]
    ds_read_b128 v[56:59], v225 offset:1024
    ds_read_b64 v[24:25], v224 offset:2560
    v_mfma_f32_16x16x32_bf16 v[120:123], a[184:187], a[208:211], v[120:123]
    ds_read_b64 v[26:27], v224 offset:2568
    ds_read_b128 v[60:63], v225 offset:1536
    v_mfma_f32_16x16x32_bf16 v[124:127], a[176:179], a[220:223], v[124:127]
    ds_read_b64 v[28:29], v224 offset:2048
    ds_read_b64 v[30:31], v224 offset:2056
    v_mfma_f32_16x16x32_bf16 v[124:127], a[180:183], a[216:219], v[124:127]
    ds_read_b128 v[64:67], v225 offset:2048
    ds_read_b64 v[32:33], v224 offset:1536
    v_mfma_f32_16x16x32_bf16 v[124:127], a[184:187], a[212:215], v[124:127]
    ds_read_b64 v[34:35], v224 offset:1544
    ds_read_b128 v[68:71], v225 offset:2560
    v_mfma_f32_16x16x32_bf16 v[124:127], a[188:191], a[208:211], v[124:127]
    ds_read_b64 v[36:37], v224 offset:1024
    ds_read_b64 v[38:39], v224 offset:1032
    v_mfma_f32_16x16x32_bf16 v[128:131], a[176:179], a[224:227], v[128:131]
    ds_read_b128 v[72:75], v225 offset:3072
    ds_read_b64 v[40:41], v224 offset:512
    v_mfma_f32_16x16x32_bf16 v[128:131], a[180:183], a[220:223], v[128:131]
    ds_read_b64 v[42:43], v224 offset:520
    ds_read_b128 v[76:79], v225 offset:3584
    v_mfma_f32_16x16x32_bf16 v[128:131], a[184:187], a[216:219], v[128:131]
    ds_read_b64 v[44:45], v224 offset:0
    ds_read_b64 v[46:47], v224 offset:8
    v_mfma_f32_16x16x32_bf16 v[128:131], a[188:191], a[212:215], v[128:131]
    buffer_load_dwordx4 v227, s[48:51], s12 offen offset:1024 lds
    s_add_u32 m0, s87, 41216
    v_mfma_f32_16x16x32_bf16 v[128:131], a[192:195], a[208:211], v[128:131]
    buffer_load_dwordx4 v226, s[48:51], s13 offen offset:0 lds
    buffer_load_dwordx4 v227, s[48:51], s13 offen offset:1024 lds
    v_mfma_f32_16x16x32_bf16 v[132:135], a[176:179], a[228:231], v[132:135]
    s_add_u32 m0, s87, 43264
    s_nop 0
    buffer_load_dwordx4 v226, s[48:51], s14 offen offset:0 lds
    v_mfma_f32_16x16x32_bf16 v[132:135], a[180:183], a[224:227], v[132:135]
    buffer_load_dwordx4 v227, s[48:51], s14 offen offset:1024 lds
    s_add_u32 m0, s87, 45312
    v_mfma_f32_16x16x32_bf16 v[132:135], a[184:187], a[220:223], v[132:135]
    buffer_load_dwordx4 v226, s[48:51], s15 offen offset:0 lds
    s_waitcnt vmcnt(15)
    ds_read_b64_tr_b16 a[24:25], v230 offset:6144
    v_mfma_f32_16x16x32_bf16 v[132:135], a[188:191], a[216:219], v[132:135]
    ds_read_b64_tr_b16 a[26:27], v230 offset:7168
    ds_read_b64_tr_b16 a[28:29], v231 offset:6144
    v_mfma_f32_16x16x32_bf16 v[132:135], a[192:195], a[212:215], v[132:135]
    ds_read_b64_tr_b16 a[30:31], v231 offset:7168
    buffer_load_dwordx4 v227, s[48:51], s15 offen offset:1024 lds
    v_mfma_f32_16x16x32_bf16 v[132:135], a[196:199], a[208:211], v[132:135]
    s_waitcnt vmcnt(14)
    ds_read_b64_tr_b16 a[32:33], v228 offset:0
    ds_read_b64_tr_b16 a[34:35], v228 offset:1024
    v_mfma_f32_16x16x32_bf16 v[136:139], a[176:179], a[232:235], v[136:139]
    ds_read_b64_tr_b16 a[36:37], v229 offset:0
    ds_read_b64_tr_b16 a[38:39], v229 offset:1024
    v_mfma_f32_16x16x32_bf16 v[136:139], a[180:183], a[228:231], v[136:139]
    s_waitcnt vmcnt(12)
    ds_read_b64_tr_b16 a[40:41], v228 offset:2048
    ds_read_b64_tr_b16 a[42:43], v228 offset:3072
    v_mfma_f32_16x16x32_bf16 v[136:139], a[184:187], a[224:227], v[136:139]
    ds_read_b64_tr_b16 a[44:45], v229 offset:2048
    ds_read_b64_tr_b16 a[46:47], v229 offset:3072
    v_mfma_f32_16x16x32_bf16 v[136:139], a[188:191], a[220:223], v[136:139]
    s_add_u32 m0, s87, 47360
    s_nop 0
    buffer_load_dwordx4 v226, s[48:51], s16 offen offset:0 lds
    v_mfma_f32_16x16x32_bf16 v[136:139], a[192:195], a[216:219], v[136:139]
    buffer_load_dwordx4 v227, s[48:51], s16 offen offset:1024 lds
    s_add_u32 m0, s87, 49408
    v_mfma_f32_16x16x32_bf16 v[136:139], a[196:199], a[212:215], v[136:139]
    buffer_load_dwordx4 v226, s[48:51], s17 offen offset:0 lds
    buffer_load_dwordx4 v227, s[48:51], s17 offen offset:1024 lds
    v_mfma_f32_16x16x32_bf16 v[136:139], a[200:203], a[208:211], v[136:139]
    s_mov_b32 m0, s88
    s_waitcnt lgkmcnt(15)
    buffer_load_dwordx4 v226, s[48:51], s18 offen offset:0 lds
    v_mfma_f32_16x16x32_bf16 v[140:143], a[176:179], a[236:239], v[140:143]
    buffer_load_dwordx4 v227, s[48:51], s18 offen offset:1024 lds
    s_add_u32 m0, s88, 2048
    s_waitcnt lgkmcnt(15)
    v_mfma_f32_16x16x32_bf16 v[140:143], a[180:183], a[232:235], v[140:143]
    buffer_load_dwordx4 v226, s[48:51], s19 offen offset:0 lds
    buffer_load_dwordx4 v227, s[48:51], s19 offen offset:1024 lds
    v_mfma_f32_16x16x32_bf16 v[140:143], a[184:187], a[228:231], v[140:143]
    s_add_u32 m0, s88, 4096
    s_waitcnt lgkmcnt(15)
    buffer_load_dwordx4 v226, s[48:51], s20 offen offset:0 lds
    v_mfma_f32_16x16x32_bf16 v[140:143], a[188:191], a[224:227], v[140:143]
    v_mfma_f32_16x16x32_bf16 v[140:143], a[192:195], a[220:223], v[140:143]
    s_waitcnt vmcnt(19)
    ds_read_b64_tr_b16 a[48:49], v228 offset:4096
    ds_read_b64_tr_b16 a[50:51], v228 offset:5120
    v_mfma_f32_16x16x32_bf16 v[140:143], a[196:199], a[216:219], v[140:143]
    ds_read_b64_tr_b16 a[52:53], v229 offset:4096
    ds_read_b64_tr_b16 a[54:55], v229 offset:5120
    v_mfma_f32_16x16x32_bf16 v[140:143], a[200:203], a[212:215], v[140:143]
    buffer_load_dwordx4 v227, s[48:51], s20 offen offset:1024 lds
    s_waitcnt vmcnt(18)
    ds_read_b64_tr_b16 a[56:57], v228 offset:6144
    v_mfma_f32_16x16x32_bf16 v[140:143], a[204:207], a[208:211], v[140:143]
    s_waitcnt lgkmcnt(15)
    v_mfma_f32_16x16x32_bf16 v[112:115], v[16:19], v[48:51], v[112:115]
    s_barrier
    ds_read_b64_tr_b16 a[58:59], v228 offset:7168
    ds_read_b64_tr_b16 a[60:61], v229 offset:6144
    v_mfma_f32_16x16x32_bf16 v[116:119], v[16:19], v[52:55], v[116:119]
    ds_read_b64_tr_b16 a[62:63], v229 offset:7168
    buffer_load_dword v100, v249, s[52:55], 0 offen sc1
    v_mfma_f32_16x16x32_bf16 v[116:119], v[20:23], v[48:51], v[116:119]
    s_add_u32 m0, s88, 6144
    s_waitcnt lgkmcnt(15)
    buffer_load_dwordx4 v226, s[48:51], s21 offen offset:0 lds
    v_mfma_f32_16x16x32_bf16 v[120:123], v[16:19], v[56:59], v[120:123]
    s_waitcnt vmcnt(18)
    ds_read_b64_tr_b16 a[64:65], v228 offset:8192
    ds_read_b64_tr_b16 a[66:67], v228 offset:9216
    v_mfma_f32_16x16x32_bf16 v[120:123], v[20:23], v[52:55], v[120:123]
    ds_read_b64_tr_b16 a[68:69], v229 offset:8192
    ds_read_b64_tr_b16 a[70:71], v229 offset:9216
    v_mfma_f32_16x16x32_bf16 v[120:123], v[24:27], v[48:51], v[120:123]
    buffer_load_dwordx4 v227, s[48:51], s21 offen offset:1024 lds
    s_mov_b32 m0, s87
    s_waitcnt lgkmcnt(15)
    v_mfma_f32_16x16x32_bf16 v[124:127], v[16:19], v[60:63], v[124:127]
    buffer_load_dwordx4 v226, s[48:51], s22 offen offset:0 lds
    buffer_load_dwordx4 v227, s[48:51], s22 offen offset:1024 lds
    v_mfma_f32_16x16x32_bf16 v[124:127], v[20:23], v[56:59], v[124:127]
    v_mfma_f32_16x16x32_bf16 v[124:127], v[24:27], v[52:55], v[124:127]
    v_mfma_f32_16x16x32_bf16 v[124:127], v[28:31], v[48:51], v[124:127]
    s_add_u32 m0, s87, 2048
    s_waitcnt lgkmcnt(12)
    buffer_load_dwordx4 v226, s[48:51], s23 offen offset:0 lds
    v_mfma_f32_16x16x32_bf16 v[128:131], v[16:19], v[64:67], v[128:131]
    v_mfma_f32_16x16x32_bf16 v[128:131], v[20:23], v[60:63], v[128:131]
    buffer_load_dwordx4 v227, s[48:51], s23 offen offset:1024 lds
    v_mfma_f32_16x16x32_bf16 v[128:131], v[24:27], v[56:59], v[128:131]
    v_mfma_f32_16x16x32_bf16 v[128:131], v[28:31], v[52:55], v[128:131]
    v_mfma_f32_16x16x32_bf16 v[128:131], v[32:35], v[48:51], v[128:131]
    s_add_u32 m0, s87, 4096
    s_waitcnt lgkmcnt(8)
    buffer_load_dwordx4 v226, s[48:51], s24 offen offset:0 lds
    v_mfma_f32_16x16x32_bf16 v[132:135], v[16:19], v[68:71], v[132:135]
    v_mfma_f32_16x16x32_bf16 v[132:135], v[20:23], v[64:67], v[132:135]
    buffer_load_dwordx4 v227, s[48:51], s24 offen offset:1024 lds
    v_mfma_f32_16x16x32_bf16 v[132:135], v[24:27], v[60:63], v[132:135]
    v_mfma_f32_16x16x32_bf16 v[132:135], v[28:31], v[56:59], v[132:135]
    v_mfma_f32_16x16x32_bf16 v[132:135], v[32:35], v[52:55], v[132:135]
    s_add_u32 m0, s87, 6144
    s_waitcnt lgkmcnt(4)
    buffer_load_dwordx4 v226, s[48:51], s25 offen offset:0 lds
    v_mfma_f32_16x16x32_bf16 v[132:135], v[36:39], v[48:51], v[132:135]
    v_mfma_f32_16x16x32_bf16 v[136:139], v[16:19], v[72:75], v[136:139]
    buffer_load_dwordx4 v227, s[48:51], s25 offen offset:1024 lds
    v_mfma_f32_16x16x32_bf16 v[136:139], v[20:23], v[68:71], v[136:139]
    v_mfma_f32_16x16x32_bf16 v[136:139], v[24:27], v[64:67], v[136:139]
    v_mfma_f32_16x16x32_bf16 v[136:139], v[28:31], v[60:63], v[136:139]
    v_mfma_f32_16x16x32_bf16 v[136:139], v[32:35], v[56:59], v[136:139]
    v_mfma_f32_16x16x32_bf16 v[136:139], v[36:39], v[52:55], v[136:139]
    v_mfma_f32_16x16x32_bf16 v[136:139], v[40:43], v[48:51], v[136:139]
    v_mfma_f32_16x16x32_bf16 v[140:143], v[16:19], v[76:79], v[140:143]
    s_waitcnt vmcnt(10)
    v_cmp_ne_u32 vcc, 4, v100
    s_cbranch_vccnz RT_13
OK_12:
    v_mfma_f32_16x16x32_bf16 v[140:143], v[20:23], v[72:75], v[140:143]
    s_lshr_b32 s26, s4, 4
    buffer_load_dwordx4 v[144:147], v232, s[52:55], s26 offen sc1
    v_mfma_f32_16x16x32_bf16 v[140:143], v[24:27], v[68:71], v[140:143]
    v_mfma_f32_16x16x32_bf16 v[140:143], v[28:31], v[64:67], v[140:143]
    buffer_load_dwordx4 v[148:151], v233, s[52:55], s26 offen sc1
    v_mfma_f32_16x16x32_bf16 v[140:143], v[32:35], v[60:63], v[140:143]
    v_mfma_f32_16x16x32_bf16 v[140:143], v[36:39], v[56:59], v[140:143]
    v_mfma_f32_16x16x32_bf16 v[140:143], v[40:43], v[52:55], v[140:143]
    s_lshr_b32 s26, s5, 4
    buffer_load_dwordx4 v[152:155], v232, s[52:55], s26 offen sc1
    v_mfma_f32_16x16x32_bf16 v[140:143], v[44:47], v[48:51], v[140:143]
    buffer_load_dwordx4 v[156:159], v233, s[52:55], s26 offen sc1
    s_lshr_b32 s26, s6, 4
    buffer_load_dwordx4 v[160:163], v232, s[52:55], s26 offen sc1
    buffer_load_dwordx4 v[164:167], v233, s[52:55], s26 offen sc1
    s_lshr_b32 s26, s7, 4
    buffer_load_dwordx4 v[168:171], v232, s[52:55], s26 offen sc1
    buffer_load_dwordx4 v[172:175], v233, s[52:55], s26 offen sc1
    s_lshl_b32 s27, s66, 12
    s_add_u32 s27, s27, 131840
    v_add_u32 v96, s27, v248
    s_xor_b32 s28, s66, 1
    s_lshl_b32 s28, s28, 12
    s_add_u32 s28, s28, 131840
    v_add_u32 v97, s28, v248
    s_bitcmp1_b32 s66, 0
    s_cbranch_scc1 H1_15
    s_nop 1
    ds_write_b128 v96, v[128:131] offset:0
    ds_write_b128 v96, v[132:135] offset:1024
    ds_write_b128 v96, v[136:139] offset:2048
    ds_write_b128 v96, v[140:143] offset:3072
    s_lshr_b32 s26, s8, 4
    buffer_load_dwordx4 v[176:179], v232, s[52:55], s26 offen sc1
    buffer_load_dwordx4 v[180:183], v233, s[52:55], s26 offen sc1
    s_lshr_b32 s26, s9, 4
    buffer_load_dwordx4 v[184:187], v232, s[52:55], s26 offen sc1
    s_waitcnt lgkmcnt(0)
    s_barrier
    ds_read_b128 v[80:83], v97 offset:0
    ds_read_b128 v[84:87], v97 offset:1024
    ds_read_b128 v[88:91], v97 offset:2048
    ds_read_b128 v[92:95], v97 offset:3072
    s_waitcnt lgkmcnt(3)
    v_pk_add_f32 v[80:81], v[80:81], v[112:113]
    v_pk_add_f32 v[82:83], v[82:83], v[114:115]
    s_waitcnt lgkmcnt(2)
    v_pk_add_f32 v[84:85], v[84:85], v[116:117]
    v_pk_add_f32 v[86:87], v[86:87], v[118:119]
    s_waitcnt lgkmcnt(1)
    v_pk_add_f32 v[88:89], v[88:89], v[120:121]
    v_pk_add_f32 v[90:91], v[90:91], v[122:123]
    s_waitcnt lgkmcnt(0)
    v_pk_add_f32 v[92:93], v[92:93], v[124:125]
    v_pk_add_f32 v[94:95], v[94:95], v[126:127]
    s_branch HE_16
H1_15:
    ds_write_b128 v96, v[112:115] offset:0
    ds_write_b128 v96, v[116:119] offset:1024
    ds_write_b128 v96, v[120:123] offset:2048
    ds_write_b128 v96, v[124:127] offset:3072
    s_lshr_b32 s26, s8, 4
    buffer_load_dwordx4 v[176:179], v232, s[52:55], s26 offen sc1
    buffer_load_dwordx4 v[180:183], v233, s[52:55], s26 offen sc1
    s_lshr_b32 s26, s9, 4
    buffer_load_dwordx4 v[184:187], v232, s[52:55], s26 offen sc1
    s_waitcnt lgkmcnt(0)
    s_barrier
    ds_read_b128 v[80:83], v97 offset:0
    ds_read_b128 v[84:87], v97 offset:1024
    ds_read_b128 v[88:91], v97 offset:2048
    ds_read_b128 v[92:95], v97 offset:3072
    s_waitcnt lgkmcnt(3)
    v_pk_add_f32 v[80:81], v[80:81], v[128:129]
    v_pk_add_f32 v[82:83], v[82:83], v[130:131]
    s_waitcnt lgkmcnt(2)
    v_pk_add_f32 v[84:85], v[84:85], v[132:133]
    v_pk_add_f32 v[86:87], v[86:87], v[134:135]
    s_waitcnt lgkmcnt(1)
    v_pk_add_f32 v[88:89], v[88:89], v[136:137]
    v_pk_add_f32 v[90:91], v[90:91], v[138:139]
    s_waitcnt lgkmcnt(0)
    v_pk_add_f32 v[92:93], v[92:93], v[140:141]
    v_pk_add_f32 v[94:95], v[94:95], v[142:143]
HE_16:
    v_cvt_pk_bf16_f32 v112, v80, v81
    v_cvt_pk_bf16_f32 v113, v82, v83
    v_cvt_pk_bf16_f32 v114, v84, v85
    v_cvt_pk_bf16_f32 v115, v86, v87
    v_cvt_pk_bf16_f32 v116, v88, v89
    v_cvt_pk_bf16_f32 v117, v90, v91
    v_cvt_pk_bf16_f32 v118, v92, v93
    v_cvt_pk_bf16_f32 v119, v94, v95
    s_nop 0
    v_permlane16_swap_b32 v112, v114
    v_permlane16_swap_b32 v113, v115
    v_permlane16_swap_b32 v116, v118
    v_permlane16_swap_b32 v117, v119
    buffer_load_dwordx4 v[188:191], v233, s[52:55], s26 offen sc1
    s_lshr_b32 s26, s10, 4
    buffer_load_dwordx4 a[240:243], v232, s[52:55], s26 offen sc1
    buffer_load_dwordx4 a[244:247], v233, s[52:55], s26 offen sc1
    s_lshr_b32 s26, s11, 4
    buffer_load_dwordx4 a[248:251], v232, s[52:55], s26 offen sc1
    buffer_load_dwordx4 a[252:255], v233, s[52:55], s26 offen sc1
    buffer_store_dwordx4 v[112:115], v247, s[52:55], 0 offen offset:0 sc1
    buffer_store_dwordx4 v[116:119], v247, s[52:55], 0 offen offset:1024 sc1
    s_waitcnt vmcnt(16)
    v_mfma_f32_32x32x16_bf16 v[64:79], a[4:7], v[148:151], 0
    s_lshr_b32 s26, s12, 4
    buffer_load_dwordx4 a[176:179], v232, s[52:55], s26 offen sc1
    buffer_load_dwordx4 a[180:183], v233, s[52:55], s26 offen sc1
    v_mfma_f32_32x32x16_bf16 v[48:63], a[4:7], v[144:147], 0
    v_mfma_f32_32x32x16_bf16 v[32:47], a[0:3], v[148:151], 0
    v_mfma_f32_32x32x16_bf16 v[16:31], a[0:3], v[144:147], 0
    s_waitcnt vmcnt(16)
    v_mfma_f32_32x32x16_bf16 v[64:79], a[12:15], v[156:159], v[64:79]
    s_lshr_b32 s26, s13, 4
    buffer_load_dwordx4 v[144:147], v232, s[52:55], s26 offen sc1
    buffer_load_dwordx4 v[148:151], v233, s[52:55], s26 offen sc1
    v_mfma_f32_32x32x16_bf16 v[48:63], a[12:15], v[152:155], v[48:63]
    v_mfma_f32_32x32x16_bf16 v[32:47], a[8:11], v[156:159], v[32:47]
    v_mfma_f32_32x32x16_bf16 v[16:31], a[8:11], v[152:155], v[16:31]
    s_waitcnt vmcnt(16)
    v_mfma_f32_32x32x16_bf16 v[64:79], a[20:23], v[164:167], v[64:79]
    s_lshr_b32 s26, s14, 4
    buffer_load_dwordx4 v[152:155], v232, s[52:55], s26 offen sc1
    buffer_load_dwordx4 v[156:159], v233, s[52:55], s26 offen sc1
    v_mfma_f32_32x32x16_bf16 v[48:63], a[20:23], v[160:163], v[48:63]
    v_mfma_f32_32x32x16_bf16 v[32:47], a[16:19], v[164:167], v[32:47]
    v_mfma_f32_32x32x16_bf16 v[16:31], a[16:19], v[160:163], v[16:31]
    s_waitcnt vmcnt(16)
    v_mfma_f32_32x32x16_bf16 v[64:79], a[28:31], v[172:175], v[64:79]
    s_lshr_b32 s26, s15, 4
    buffer_load_dwordx4 v[160:163], v232, s[52:55], s26 offen sc1
    buffer_load_dwordx4 v[164:167], v233, s[52:55], s26 offen sc1
    v_mfma_f32_32x32x16_bf16 v[48:63], a[28:31], v[168:171], v[48:63]
    v_mfma_f32_32x32x16_bf16 v[32:47], a[24:27], v[172:175], v[32:47]
    v_mfma_f32_32x32x16_bf16 v[16:31], a[24:27], v[168:171], v[16:31]
    s_waitcnt vmcnt(16)
    v_mfma_f32_32x32x16_bf16 v[64:79], a[36:39], v[180:183], v[64:79]
    s_lshr_b32 s26, s16, 4
    buffer_load_dwordx4 v[168:171], v232, s[52:55], s26 offen sc1
    buffer_load_dwordx4 v[172:175], v233, s[52:55], s26 offen sc1
    v_mfma_f32_32x32x16_bf16 v[48:63], a[36:39], v[176:179], v[48:63]
    v_mfma_f32_32x32x16_bf16 v[32:47], a[32:35], v[180:183], v[32:47]
    v_mfma_f32_32x32x16_bf16 v[16:31], a[32:35], v[176:179], v[16:31]
    s_waitcnt vmcnt(16)
    v_mfma_f32_32x32x16_bf16 v[64:79], a[44:47], v[188:191], v[64:79]
    s_lshr_b32 s26, s17, 4
    buffer_load_dwordx4 v[176:179], v232, s[52:55], s26 offen sc1
    buffer_load_dwordx4 v[180:183], v233, s[52:55], s26 offen sc1
    v_mfma_f32_32x32x16_bf16 v[48:63], a[44:47], v[184:187], v[48:63]
    v_mfma_f32_32x32x16_bf16 v[32:47], a[40:43], v[188:191], v[32:47]
    v_mfma_f32_32x32x16_bf16 v[16:31], a[40:43], v[184:187], v[16:31]
    s_waitcnt vmcnt(16)
    v_mfma_f32_32x32x16_bf16 v[64:79], a[52:55], a[244:247], v[64:79]
    s_waitcnt vmcnt(55)
    ds_read_b64_tr_b16 a[72:73], v228 offset:41216
    ds_read_b64_tr_b16 a[74:75], v228 offset:42240
    ds_read_b64_tr_b16 a[76:77], v229 offset:41216
    v_mfma_f32_32x32x16_bf16 v[48:63], a[52:55], a[240:243], v[48:63]
    ds_read_b64_tr_b16 a[78:79], v229 offset:42240
    s_lshr_b32 s26, s18, 4
    buffer_load_dwordx4 v[184:187], v232, s[52:55], s26 offen sc1
    buffer_load_dwordx4 v[188:191], v233, s[52:55], s26 offen sc1
    v_mfma_f32_32x32x16_bf16 v[32:47], a[48:51], a[244:247], v[32:47]
    v_add_u32 v96, s87, v248
    v_add_u32 v97, s88, v248
    s_xor_b32 s27, s66, 1
    v_mfma_f32_32x32x16_bf16 v[16:31], a[48:51], a[240:243], v[16:31]
    s_mul_i32 s27, s27, 10240
    s_add_u32 s27, s27, 0
    v_add_u32 v98, s27, v248
    s_xor_b32 s27, s66, 2
    s_mul_i32 s27, s27, 10240
    s_add_u32 s27, s27, 4096
    v_add_u32 v99, s27, v248
    s_xor_b32 s27, s66, 3
    s_mul_i32 s27, s27, 8192
    s_add_u32 s27, s27, 82432
    v_add_u32 v100, s27, v248
    s_waitcnt vmcnt(16)
    v_mfma_f32_32x32x16_bf16 v[64:79], a[60:63], a[252:255], v[64:79]
    s_waitcnt vmcnt(55)
    ds_read_b64_tr_b16 a[80:81], v228 offset:43264
    ds_read_b64_tr_b16 a[82:83], v228 offset:44288
    ds_read_b64_tr_b16 a[84:85], v229 offset:43264
    v_mfma_f32_32x32x16_bf16 v[48:63], a[60:63], a[248:251], v[48:63]
    ds_read_b64_tr_b16 a[86:87], v229 offset:44288
    s_lshr_b32 s26, s19, 4
    buffer_load_dwordx4 a[240:243], v232, s[52:55], s26 offen sc1
    buffer_load_dwordx4 a[244:247], v233, s[52:55], s26 offen sc1
    v_mfma_f32_32x32x16_bf16 v[32:47], a[56:59], a[252:255], v[32:47]
    v_mfma_f32_32x32x16_bf16 v[16:31], a[56:59], a[248:251], v[16:31]
    s_waitcnt vmcnt(14)
    v_mfma_f32_32x32x16_bf16 v[64:79], a[68:71], a[180:183], v[64:79]
    s_waitcnt vmcnt(55)
    ds_read_b64_tr_b16 a[88:89], v228 offset:45312
    ds_read_b64_tr_b16 a[90:91], v228 offset:46336
    ds_read_b64_tr_b16 a[92:93], v229 offset:45312
    v_mfma_f32_32x32x16_bf16 v[48:63], a[68:71], a[176:179], v[48:63]
    ds_read_b64_tr_b16 a[94:95], v229 offset:46336
    s_lshr_b32 s26, s20, 4
    buffer_load_dwordx4 a[248:251], v232, s[52:55], s26 offen sc1
    buffer_load_dwordx4 a[252:255], v233, s[52:55], s26 offen sc1
    v_mfma_f32_32x32x16_bf16 v[32:47], a[64:67], a[180:183], v[32:47]
    v_mfma_f32_32x32x16_bf16 v[16:31], a[64:67], a[176:179], v[16:31]
    s_waitcnt vmcnt(14) lgkmcnt(8)
    v_mfma_f32_32x32x16_bf16 v[64:79], a[76:79], v[148:151], v[64:79]
    s_waitcnt vmcnt(55)
    ds_read_b64_tr_b16 a[96:97], v228 offset:47360
    ds_read_b64_tr_b16 a[98:99], v228 offset:48384
    ds_read_b64_tr_b16 a[100:101], v229 offset:47360
    v_mfma_f32_32x32x16_bf16 v[48:63], a[76:79], v[144:147], v[48:63]
    ds_read_b64_tr_b16 a[102:103], v229 offset:48384
    s_lshr_b32 s26, s21, 4
    buffer_load_dwordx4 a[176:179], v232, s[52:55], s26 offen sc1
    buffer_load_dwordx4 a[180:183], v233, s[52:55], s26 offen sc1
    v_mfma_f32_32x32x16_bf16 v[32:47], a[72:75], v[148:151], v[32:47]
    v_mfma_f32_32x32x16_bf16 v[16:31], a[72:75], v[144:147], v[16:31]
    s_waitcnt vmcnt(14) lgkmcnt(8)
    v_mfma_f32_32x32x16_bf16 v[64:79], a[84:87], v[156:159], v[64:79]
    s_waitcnt vmcnt(55)
    ds_read_b64_tr_b16 a[104:105], v228 offset:49408
    ds_read_b64_tr_b16 a[106:107], v228 offset:50432
    ds_read_b64_tr_b16 a[108:109], v229 offset:49408
    v_mfma_f32_32x32x16_bf16 v[48:63], a[84:87], v[152:155], v[48:63]
    ds_read_b64_tr_b16 a[110:111], v229 offset:50432
    s_lshr_b32 s26, s22, 4
    buffer_load_dwordx4 v[144:147], v232, s[52:55], s26 offen sc1
    buffer_load_dwordx4 v[148:151], v233, s[52:55], s26 offen sc1
    v_mfma_f32_32x32x16_bf16 v[32:47], a[80:83], v[156:159], v[32:47]
    v_mfma_f32_32x32x16_bf16 v[16:31], a[80:83], v[152:155], v[16:31]
    s_waitcnt vmcnt(14) lgkmcnt(8)
    v_mfma_f32_32x32x16_bf16 v[64:79], a[92:95], v[164:167], v[64:79]
    s_waitcnt vmcnt(55)
    ds_read_b64_tr_b16 a[112:113], v230 offset:0
    ds_read_b64_tr_b16 a[114:115], v230 offset:1024
    ds_read_b64_tr_b16 a[116:117], v231 offset:0
    v_mfma_f32_32x32x16_bf16 v[48:63], a[92:95], v[160:163], v[48:63]
    ds_read_b64_tr_b16 a[118:119], v231 offset:1024
    s_lshr_b32 s26, s23, 4
    buffer_load_dwordx4 v[152:155], v232, s[52:55], s26 offen sc1
    buffer_load_dwordx4 v[156:159], v233, s[52:55], s26 offen sc1
    v_mfma_f32_32x32x16_bf16 v[32:47], a[88:91], v[164:167], v[32:47]
    v_mfma_f32_32x32x16_bf16 v[16:31], a[88:91], v[160:163], v[16:31]
    s_waitcnt vmcnt(14) lgkmcnt(8)
    v_mfma_f32_32x32x16_bf16 v[64:79], a[100:103], v[172:175], v[64:79]
    s_waitcnt vmcnt(55)
    ds_read_b64_tr_b16 a[120:121], v230 offset:2048
    ds_read_b64_tr_b16 a[122:123], v230 offset:3072
    ds_read_b64_tr_b16 a[124:125], v231 offset:2048
    v_mfma_f32_32x32x16_bf16 v[48:63], a[100:103], v[168:171], v[48:63]
    ds_read_b64_tr_b16 a[126:127], v231 offset:3072
    s_lshr_b32 s26, s24, 4
    buffer_load_dwordx4 v[160:163], v232, s[52:55], s26 offen sc1
    buffer_load_dwordx4 v[164:167], v233, s[52:55], s26 offen sc1
    v_mfma_f32_32x32x16_bf16 v[32:47], a[96:99], v[172:175], v[32:47]
    v_mfma_f32_32x32x16_bf16 v[16:31], a[96:99], v[168:171], v[16:31]
    s_waitcnt vmcnt(14) lgkmcnt(8)
    v_mfma_f32_32x32x16_bf16 v[64:79], a[108:111], v[180:183], v[64:79]
    s_waitcnt vmcnt(55)
    ds_read_b64_tr_b16 a[128:129], v230 offset:4096
    ds_read_b64_tr_b16 a[130:131], v230 offset:5120
    ds_read_b64_tr_b16 a[132:133], v231 offset:4096
    v_mfma_f32_32x32x16_bf16 v[48:63], a[108:111], v[176:179], v[48:63]
    ds_read_b64_tr_b16 a[134:135], v231 offset:5120
    s_lshr_b32 s26, s25, 4
    buffer_load_dwordx4 v[168:171], v232, s[52:55], s26 offen sc1
    buffer_load_dwordx4 v[172:175], v233, s[52:55], s26 offen sc1
    v_mfma_f32_32x32x16_bf16 v[32:47], a[104:107], v[180:183], v[32:47]
    v_mfma_f32_32x32x16_bf16 v[16:31], a[104:107], v[176:179], v[16:31]
    s_waitcnt vmcnt(14) lgkmcnt(8)
    v_mfma_f32_32x32x16_bf16 v[64:79], a[116:119], v[188:191], v[64:79]
    s_waitcnt vmcnt(54)
    ds_read_b64_tr_b16 a[136:137], v230 offset:6144
    ds_read_b64_tr_b16 a[138:139], v230 offset:7168
    ds_read_b64_tr_b16 a[140:141], v231 offset:6144
    v_mfma_f32_32x32x16_bf16 v[48:63], a[116:119], v[184:187], v[48:63]
    ds_read_b64_tr_b16 a[142:143], v231 offset:7168
    buffer_load_dwordx4 v[104:107], v242, s[36:39], 0 offen
    buffer_load_dwordx4 v[108:111], v242, s[36:39], 0 offen offset:32
    v_mfma_f32_32x32x16_bf16 v[32:47], a[112:115], v[188:191], v[32:47]
    v_mfma_f32_32x32x16_bf16 v[16:31], a[112:115], v[184:187], v[16:31]
    s_waitcnt vmcnt(14) lgkmcnt(8)
    v_mfma_f32_32x32x16_bf16 v[64:79], a[124:127], a[244:247], v[64:79]
    s_waitcnt vmcnt(54)
    ds_read_b64_tr_b16 a[144:145], v228 offset:0
    ds_read_b64_tr_b16 a[146:147], v228 offset:1024
    ds_read_b64_tr_b16 a[148:149], v229 offset:0
    v_mfma_f32_32x32x16_bf16 v[48:63], a[124:127], a[240:243], v[48:63]
    ds_read_b64_tr_b16 a[150:151], v229 offset:1024
    buffer_load_dword v103, v243, s[52:55], 0 offen sc1
    v_mfma_f32_32x32x16_bf16 v[32:47], a[120:123], a[244:247], v[32:47]
    v_mfma_f32_32x32x16_bf16 v[16:31], a[120:123], a[240:243], v[16:31]
    s_waitcnt vmcnt(13) lgkmcnt(8)
    v_mfma_f32_32x32x16_bf16 v[64:79], a[132:135], a[252:255], v[64:79]
    s_waitcnt vmcnt(53)
    ds_read_b64_tr_b16 a[152:153], v228 offset:2048
    ds_read_b64_tr_b16 a[154:155], v228 offset:3072
    ds_read_b64_tr_b16 a[156:157], v229 offset:2048
    v_mfma_f32_32x32x16_bf16 v[48:63], a[132:135], a[248:251], v[48:63]
    ds_read_b64_tr_b16 a[158:159], v229 offset:3072
    v_mfma_f32_32x32x16_bf16 v[32:47], a[128:131], a[252:255], v[32:47]
    v_mfma_f32_32x32x16_bf16 v[16:31], a[128:131], a[248:251], v[16:31]
    s_waitcnt vmcnt(11) lgkmcnt(8)
    v_mfma_f32_32x32x16_bf16 v[64:79], a[140:143], a[180:183], v[64:79]
    s_waitcnt vmcnt(51)
    ds_read_b64_tr_b16 a[160:161], v228 offset:4096
    ds_read_b64_tr_b16 a[162:163], v228 offset:5120
    ds_read_b64_tr_b16 a[164:165], v229 offset:4096
    v_mfma_f32_32x32x16_bf16 v[48:63], a[140:143], a[176:179], v[48:63]
    ds_read_b64_tr_b16 a[166:167], v229 offset:5120
    buffer_load_dwordx4 v[112:115], v244, s[52:55], 0 offen sc1
    buffer_load_dwordx4 v[116:119], v244, s[52:55], s31 offen sc1
    v_mfma_f32_32x32x16_bf16 v[32:47], a[136:139], a[180:183], v[32:47]
    v_mfma_f32_32x32x16_bf16 v[16:31], a[136:139], a[176:179], v[16:31]
    s_waitcnt vmcnt(11) lgkmcnt(8)
    v_mfma_f32_32x32x16_bf16 v[64:79], a[148:151], v[148:151], v[64:79]
    s_waitcnt vmcnt(51)
    ds_read_b64_tr_b16 a[168:169], v228 offset:6144
    ds_read_b64_tr_b16 a[170:171], v228 offset:7168
    ds_read_b64_tr_b16 a[172:173], v229 offset:6144
    v_mfma_f32_32x32x16_bf16 v[48:63], a[148:151], v[144:147], v[48:63]
    ds_read_b64_tr_b16 a[174:175], v229 offset:7168
    v_mfma_f32_32x32x16_bf16 v[32:47], a[144:147], v[148:151], v[32:47]
    v_mfma_f32_32x32x16_bf16 v[16:31], a[144:147], v[144:147], v[16:31]
    s_waitcnt vmcnt(9) lgkmcnt(8)
    v_mfma_f32_32x32x16_bf16 v[64:79], a[156:159], v[156:159], v[64:79]
    v_mfma_f32_32x32x16_bf16 v[48:63], a[156:159], v[152:155], v[48:63]
    v_mfma_f32_32x32x16_bf16 v[32:47], a[152:155], v[156:159], v[32:47]
    v_mfma_f32_32x32x16_bf16 v[16:31], a[152:155], v[152:155], v[16:31]
    s_waitcnt vmcnt(7) lgkmcnt(4)
    v_mfma_f32_32x32x16_bf16 v[64:79], a[164:167], v[164:167], v[64:79]
    v_mfma_f32_32x32x16_bf16 v[48:63], a[164:167], v[160:163], v[48:63]
    v_mfma_f32_32x32x16_bf16 v[32:47], a[160:163], v[164:167], v[32:47]
    v_mfma_f32_32x32x16_bf16 v[16:31], a[160:163], v[160:163], v[16:31]
    s_cmp_ge_u32 s66, 2
    s_cbranch_scc1 SK_17
    s_waitcnt vmcnt(5) lgkmcnt(0)
    v_mfma_f32_32x32x16_bf16 v[64:79], a[172:175], v[172:175], v[64:79]
    v_mfma_f32_32x32x16_bf16 v[48:63], a[172:175], v[168:171], v[48:63]
    v_mfma_f32_32x32x16_bf16 v[32:47], a[168:171], v[172:175], v[32:47]
    v_mfma_f32_32x32x16_bf16 v[16:31], a[168:171], v[168:171], v[16:31]
SK_17:
    s_nop 8
    ds_write_b128 v97, v[64:67] offset:0
    ds_write_b128 v97, v[68:71] offset:1024
    ds_write_b128 v97, v[72:75] offset:2048
    ds_write_b128 v97, v[76:79] offset:3072
    ds_write_b128 v96, v[48:51] offset:4096
    ds_write_b128 v96, v[52:55] offset:5120
    ds_write_b128 v96, v[56:59] offset:6144
    ds_write_b128 v96, v[60:63] offset:7168
    ds_write_b128 v96, v[32:35] offset:0
    ds_write_b128 v96, v[36:39] offset:1024
    ds_write_b128 v96, v[40:43] offset:2048
    ds_write_b128 v96, v[44:47] offset:3072
    s_waitcnt vmcnt(0)
    v_max3_u32 v101, v112, v113, v114
    v_max3_u32 v102, v115, v116, v117
    v_max3_u32 v101, v101, v118, v119
    v_max_u32 v101, v101, v102
    v_cmp_eq_u32 vcc, -1, v101
    s_cbranch_vccnz RT_19
OK_18:
    ds_write_b128 v245, v[112:115] offset:0
    ds_write_b128 v245, v[116:119] offset:1024
    ds_read_b64_tr_b16 v[120:121], v246 offset:0
    ds_read_b64_tr_b16 v[122:123], v246 offset:512
    ds_read_b64_tr_b16 v[124:125], v246 offset:1024
    ds_read_b64_tr_b16 v[126:127], v246 offset:1536
    s_waitcnt vmcnt(2)
    v_lshlrev_b32 v80, 16, v104
    v_and_b32 v81, s85, v104
    v_lshlrev_b32 v82, 16, v105
    v_and_b32 v83, s85, v105
    v_lshlrev_b32 v84, 16, v106
    v_and_b32 v85, s85, v106
    v_lshlrev_b32 v86, 16, v107
    v_and_b32 v87, s85, v107
    v_lshlrev_b32 v88, 16, v108
    v_and_b32 v89, s85, v108
    v_lshlrev_b32 v90, 16, v109
    v_and_b32 v91, s85, v109
    v_lshlrev_b32 v92, 16, v110
    v_and_b32 v93, s85, v110
    v_lshlrev_b32 v94, 16, v111
    v_and_b32 v95, s85, v111
    s_waitcnt lgkmcnt(0)
    s_barrier
    ds_read_b128 v[144:147], v98 offset:0
    ds_read_b128 v[148:151], v98 offset:1024
    ds_read_b128 v[152:155], v98 offset:2048
    ds_read_b128 v[156:159], v98 offset:3072
    ds_read_b128 v[160:163], v99 offset:0
    ds_read_b128 v[164:167], v99 offset:1024
    ds_read_b128 v[168:171], v99 offset:2048
    ds_read_b128 v[172:175], v99 offset:3072
    ds_read_b128 v[176:179], v100 offset:0
    ds_read_b128 v[180:183], v100 offset:1024
    ds_read_b128 v[184:187], v100 offset:2048
    ds_read_b128 v[188:191], v100 offset:3072
    v_lshlrev_b32 v32, 16, v120
    v_and_b32 v33, s85, v120
    v_lshlrev_b32 v34, 16, v121
    v_and_b32 v35, s85, v121
    v_lshlrev_b32 v36, 16, v122
    v_and_b32 v37, s85, v122
    v_lshlrev_b32 v38, 16, v123
    v_and_b32 v39, s85, v123
    v_lshlrev_b32 v40, 16, v124
    v_and_b32 v41, s85, v124
    v_lshlrev_b32 v42, 16, v125
    v_and_b32 v43, s85, v125
    v_lshlrev_b32 v44, 16, v126
    v_and_b32 v45, s85, v126
    v_lshlrev_b32 v46, 16, v127
    v_and_b32 v47, s85, v127
    s_waitcnt lgkmcnt(8)
    v_pk_add_f32 v[16:17], v[16:17], v[144:145]
    v_pk_add_f32 v[18:19], v[18:19], v[146:147]
    v_pk_add_f32 v[20:21], v[20:21], v[148:149]
    v_pk_add_f32 v[22:23], v[22:23], v[150:151]
    v_pk_add_f32 v[24:25], v[24:25], v[152:153]
    v_pk_add_f32 v[26:27], v[26:27], v[154:155]
    v_pk_add_f32 v[28:29], v[28:29], v[156:157]
    v_pk_add_f32 v[30:31], v[30:31], v[158:159]
    s_waitcnt lgkmcnt(4)
    v_pk_add_f32 v[16:17], v[16:17], v[160:161]
    v_pk_add_f32 v[18:19], v[18:19], v[162:163]
    v_pk_add_f32 v[20:21], v[20:21], v[164:165]
    v_pk_add_f32 v[22:23], v[22:23], v[166:167]
    v_pk_add_f32 v[24:25], v[24:25], v[168:169]
    v_pk_add_f32 v[26:27], v[26:27], v[170:171]
    v_pk_add_f32 v[28:29], v[28:29], v[172:173]
    v_pk_add_f32 v[30:31], v[30:31], v[174:175]
    s_waitcnt lgkmcnt(0)
    v_pk_add_f32 v[16:17], v[16:17], v[176:177]
    v_pk_add_f32 v[18:19], v[18:19], v[178:179]
    v_pk_add_f32 v[20:21], v[20:21], v[180:181]
    v_pk_add_f32 v[22:23], v[22:23], v[182:183]
    v_pk_add_f32 v[24:25], v[24:25], v[184:185]
    v_pk_add_f32 v[26:27], v[26:27], v[186:187]
    v_pk_add_f32 v[28:29], v[28:29], v[188:189]
    v_pk_add_f32 v[30:31], v[30:31], v[190:191]
    v_pk_fma_f32 v[16:17], v[16:17], v[102:103], v[32:33] op_sel:[0,1,0] op_sel_hi:[1,1,1]
    v_pk_fma_f32 v[18:19], v[18:19], v[102:103], v[34:35] op_sel:[0,1,0] op_sel_hi:[1,1,1]
    v_pk_fma_f32 v[20:21], v[20:21], v[102:103], v[36:37] op_sel:[0,1,0] op_sel_hi:[1,1,1]
    v_pk_fma_f32 v[22:23], v[22:23], v[102:103], v[38:39] op_sel:[0,1,0] op_sel_hi:[1,1,1]
    v_pk_fma_f32 v[24:25], v[24:25], v[102:103], v[40:41] op_sel:[0,1,0] op_sel_hi:[1,1,1]
    v_pk_fma_f32 v[26:27], v[26:27], v[102:103], v[42:43] op_sel:[0,1,0] op_sel_hi:[1,1,1]
    v_pk_fma_f32 v[28:29], v[28:29], v[102:103], v[44:45] op_sel:[0,1,0] op_sel_hi:[1,1,1]
    v_pk_fma_f32 v[30:31], v[30:31], v[102:103], v[46:47] op_sel:[0,1,0] op_sel_hi:[1,1,1]
    v_permlane32_swap_b32 v16, v20
    v_permlane32_swap_b32 v17, v21
    v_permlane32_swap_b32 v18, v22
    v_permlane32_swap_b32 v19, v23
    v_permlane32_swap_b32 v24, v28
    v_permlane32_swap_b32 v25, v29
    v_permlane32_swap_b32 v26, v30
    v_permlane32_swap_b32 v27, v31
    v_pk_add_f32 v[16:17], v[16:17], v[80:81]
    v_cvt_pk_bf16_f32 v104, v16, v17
    v_pk_add_f32 v[18:19], v[18:19], v[82:83]
    v_cvt_pk_bf16_f32 v105, v18, v19
    v_pk_add_f32 v[20:21], v[20:21], v[84:85]
    v_cvt_pk_bf16_f32 v106, v20, v21
    v_pk_add_f32 v[22:23], v[22:23], v[86:87]
    v_cvt_pk_bf16_f32 v107, v22, v23
    buffer_store_dwordx4 v[104:107], v242, s[56:59], 0 offen offset:0
    v_pk_add_f32 v[24:25], v[24:25], v[88:89]
    v_cvt_pk_bf16_f32 v108, v24, v25
    v_pk_add_f32 v[26:27], v[26:27], v[90:91]
    v_cvt_pk_bf16_f32 v109, v26, v27
    v_pk_add_f32 v[28:29], v[28:29], v[92:93]
    v_cvt_pk_bf16_f32 v110, v28, v29
    v_pk_add_f32 v[30:31], v[30:31], v[94:95]
    v_cvt_pk_bf16_f32 v111, v30, v31
    buffer_store_dwordx4 v[108:111], v242, s[56:59], 0 offen offset:32
    s_endpgm
CS_3:
    s_add_u32 m0, s77, 82432
    s_nop 0
    buffer_load_dwordx4 v204, s[40:43], s75 offen offset:0 lds
    buffer_load_dwordx4 v205, s[40:43], s75 offen offset:1024 lds
    buffer_load_dwordx4 v206, s[40:43], s75 offen offset:2048 lds
    s_add_u32 m0, m0, 12320
    s_nop 0
    buffer_load_dwordx4 v204, s[44:47], s75 offen offset:0 lds
    buffer_load_dwordx4 v205, s[44:47], s75 offen offset:1024 lds
    buffer_load_dwordx4 v206, s[44:47], s75 offen offset:2048 lds
    s_lshr_b32 s89, s89, 4
    s_and_b32 s73, s89, 7
    s_lshl_b32 s74, s73, 7
    s_mul_i32 s75, s73, 176128
    s_mul_i32 s28, s68, 768
    s_add_u32 s28, s28, 12582912
    s_cmp_eq_u32 s66, 3
    s_cselect_b32 s28, 0x80000000, s28
    v_lshl_add_u32 v241, v0, 2, s28
    s_mul_i32 s28, s66, 3072
    s_mul_i32 s29, s27, 96
    s_sub_u32 s28, s28, s29
    v_add_u32 v211, s28, v211
    v_mov_b32 v9, 0x3f803f80
    v_add_u32 v207, 41216, v211
    v_add_u32 v208, 82432, v211
    v_accvgpr_write_b32 a96, v9
    v_accvgpr_write_b32 a97, v9
    v_accvgpr_write_b32 a98, v9
    v_accvgpr_write_b32 a99, v9
    v_mov_b32 v11, -1
    s_waitcnt lgkmcnt(0)
    s_barrier
    ds_read_b64_tr_b16 a[88:89], v10 offset:0
    ds_read_b64_tr_b16 a[90:91], v10 offset:1280
    ds_read_b64_tr_b16 a[92:93], v10 offset:128
    ds_read_b64_tr_b16 a[94:95], v10 offset:1408
    s_waitcnt vmcnt(16)
    ds_read_b64_tr_b16 a[176:177], v211 offset:0
    ds_read_b64_tr_b16 a[178:179], v211 offset:768
    ds_read_b64_tr_b16 a[180:181], v211 offset:32
    ds_read_b64_tr_b16 a[182:183], v211 offset:800
    ds_read_b64_tr_b16 a[184:185], v211 offset:64
    ds_read_b64_tr_b16 a[186:187], v211 offset:832
    ds_read_b64_tr_b16 a[188:189], v211 offset:96
    ds_read_b64_tr_b16 a[190:191], v211 offset:864
    ds_read_b64_tr_b16 a[192:193], v211 offset:128
    ds_read_b64_tr_b16 a[194:195], v211 offset:896
    ds_read_b64_tr_b16 a[196:197], v211 offset:160
    ds_read_b64_tr_b16 a[198:199], v211 offset:928
    s_waitcnt lgkmcnt(0)
    v_mfma_f32_32x32x16_bf16 v[16:31], a[96:99], a[176:179], 0
    s_mov_b32 m0, s77
    s_nop 0
    buffer_load_dwordx4 v204, s[40:43], s75 offen offset:0 lds
    v_mfma_f32_32x32x16_bf16 v[32:47], a[96:99], a[180:183], 0
    buffer_load_dwordx4 v205, s[40:43], s75 offen offset:1024 lds
    buffer_load_dwordx4 v206, s[40:43], s75 offen offset:2048 lds
    v_mfma_f32_32x32x16_bf16 v[48:63], a[96:99], a[184:187], 0
    s_add_u32 m0, m0, 12320
    s_nop 0
    buffer_load_dwordx4 v204, s[44:47], s75 offen offset:0 lds
    v_mfma_f32_32x32x16_bf16 v[64:79], a[96:99], a[188:191], 0
    buffer_load_dwordx4 v205, s[44:47], s75 offen offset:1024 lds
    buffer_load_dwordx4 v206, s[44:47], s75 offen offset:2048 lds
    v_mfma_f32_32x32x16_bf16 v[80:95], a[96:99], a[192:195], 0
    s_lshr_b32 s89, s89, 4
    s_and_b32 s73, s89, 7
    v_mfma_f32_32x32x16_bf16 v[96:111], a[96:99], a[196:199], 0
    s_lshl_b32 s74, s73, 7
    s_mul_i32 s75, s73, 176128
    buffer_store_dword v11, v241, s[52:55], 0 offen sc1
    v_writelane_b32 v12, 0, 1
    buffer_store_dwordx2 v[12:13], v15, s[52:55], 0 offen sc1
    buffer_store_dwordx4 a[168:171], v247, s[52:55], 0 offen offset:0 sc1
    buffer_store_dwordx4 a[168:171], v247, s[52:55], 0 offen offset:1024 sc1
    s_waitcnt lgkmcnt(14)
    buffer_store_dwordx4 a[88:91], v14, s[52:55], 0 offen offset:0 sc1
    s_waitcnt lgkmcnt(12)
    buffer_store_dwordx4 a[92:95], v14, s[52:55], 0 offen offset:1024 sc1
    ds_write_b128 v251, v[160:163] offset:0
    ds_write_b32 v251, v168 offset:1088
    ds_write_b128 v251, v[164:167] offset:2176
    ds_write_b32 v251, v170 offset:3264
    ds_read_b64_tr_b16 a[72:73], v252 offset:0
    ds_read_b64_tr_b16 a[74:75], v252 offset:64
    ds_read_b64_tr_b16 a[76:77], v252 offset:2176
    ds_read_b64_tr_b16 a[78:79], v252 offset:2240
    ds_read_b64_tr_b16 a[80:81], v252 offset:512
    ds_read_b64_tr_b16 a[82:83], v252 offset:576
    ds_read_b64_tr_b16 a[84:85], v252 offset:2688
    ds_read_b64_tr_b16 a[86:87], v252 offset:2752
    ds_write_b128 v251, v[144:147] offset:0
    ds_write_b128 v251, v[148:151] offset:1088
    s_waitcnt vmcnt(18)
    ds_read_b64_tr_b16 a[176:177], v207 offset:0
    ds_read_b64_tr_b16 a[178:179], v207 offset:768
    ds_read_b64_tr_b16 a[180:181], v207 offset:32
    ds_read_b64_tr_b16 a[182:183], v207 offset:800
    ds_read_b64_tr_b16 a[184:185], v207 offset:64
    ds_read_b64_tr_b16 a[186:187], v207 offset:832
    ds_read_b64_tr_b16 a[188:189], v207 offset:96
    ds_read_b64_tr_b16 a[190:191], v207 offset:864
    ds_read_b64_tr_b16 a[192:193], v207 offset:128
    ds_read_b64_tr_b16 a[194:195], v207 offset:896
    ds_read_b64_tr_b16 a[196:197], v207 offset:160
    ds_read_b64_tr_b16 a[198:199], v207 offset:928
    s_waitcnt lgkmcnt(0)
    v_mfma_f32_32x32x16_bf16 v[16:31], a[96:99], a[176:179], v[16:31]
    s_add_u32 m0, s77, 41216
    s_nop 0
    buffer_load_dwordx4 v204, s[40:43], s75 offen offset:0 lds
    v_mfma_f32_32x32x16_bf16 v[32:47], a[96:99], a[180:183], v[32:47]
    buffer_load_dwordx4 v205, s[40:43], s75 offen offset:1024 lds
    buffer_load_dwordx4 v206, s[40:43], s75 offen offset:2048 lds
    v_mfma_f32_32x32x16_bf16 v[48:63], a[96:99], a[184:187], v[48:63]
    s_add_u32 m0, m0, 12320
    s_nop 0
    buffer_load_dwordx4 v204, s[44:47], s75 offen offset:0 lds
    v_mfma_f32_32x32x16_bf16 v[64:79], a[96:99], a[188:191], v[64:79]
    buffer_load_dwordx4 v205, s[44:47], s75 offen offset:1024 lds
    buffer_load_dwordx4 v206, s[44:47], s75 offen offset:2048 lds
    v_mfma_f32_32x32x16_bf16 v[80:95], a[96:99], a[192:195], v[80:95]
    s_lshr_b32 s89, s89, 4
    s_and_b32 s73, s89, 7
    v_mfma_f32_32x32x16_bf16 v[96:111], a[96:99], a[196:199], v[96:111]
    s_lshl_b32 s74, s73, 7
    s_mul_i32 s75, s73, 176128
    ds_write_b128 v251, v[152:155] offset:2176
    ds_write_b128 v251, v[156:159] offset:3264
    ds_read_b64_tr_b16 a[56:57], v252 offset:0
    ds_read_b64_tr_b16 a[58:59], v252 offset:64
    ds_read_b64_tr_b16 a[60:61], v252 offset:2176
    ds_read_b64_tr_b16 a[62:63], v252 offset:2240
    ds_read_b64_tr_b16 a[64:65], v252 offset:512
    s_waitcnt vmcnt(18)
    ds_read_b64_tr_b16 a[176:177], v208 offset:0
    ds_read_b64_tr_b16 a[178:179], v208 offset:768
    ds_read_b64_tr_b16 a[180:181], v208 offset:32
    ds_read_b64_tr_b16 a[182:183], v208 offset:800
    ds_read_b64_tr_b16 a[184:185], v208 offset:64
    ds_read_b64_tr_b16 a[186:187], v208 offset:832
    ds_read_b64_tr_b16 a[188:189], v208 offset:96
    ds_read_b64_tr_b16 a[190:191], v208 offset:864
    ds_read_b64_tr_b16 a[192:193], v208 offset:128
    ds_read_b64_tr_b16 a[194:195], v208 offset:896
    ds_read_b64_tr_b16 a[196:197], v208 offset:160
    ds_read_b64_tr_b16 a[198:199], v208 offset:928
    s_waitcnt lgkmcnt(0)
    v_mfma_f32_32x32x16_bf16 v[16:31], a[96:99], a[176:179], v[16:31]
    s_add_u32 m0, s77, 82432
    s_nop 0
    buffer_load_dwordx4 v204, s[40:43], s75 offen offset:0 lds
    v_mfma_f32_32x32x16_bf16 v[32:47], a[96:99], a[180:183], v[32:47]
    buffer_load_dwordx4 v205, s[40:43], s75 offen offset:1024 lds
    buffer_load_dwordx4 v206, s[40:43], s75 offen offset:2048 lds
    v_mfma_f32_32x32x16_bf16 v[48:63], a[96:99], a[184:187], v[48:63]
    s_add_u32 m0, m0, 12320
    s_nop 0
    buffer_load_dwordx4 v204, s[44:47], s75 offen offset:0 lds
    v_mfma_f32_32x32x16_bf16 v[64:79], a[96:99], a[188:191], v[64:79]
    buffer_load_dwordx4 v205, s[44:47], s75 offen offset:1024 lds
    buffer_load_dwordx4 v206, s[44:47], s75 offen offset:2048 lds
    v_mfma_f32_32x32x16_bf16 v[80:95], a[96:99], a[192:195], v[80:95]
    s_lshr_b32 s89, s89, 4
    s_and_b32 s73, s89, 7
    v_mfma_f32_32x32x16_bf16 v[96:111], a[96:99], a[196:199], v[96:111]
    s_lshl_b32 s74, s73, 7
    s_mul_i32 s75, s73, 176128
    s_waitcnt vmcnt(12)
    s_barrier
    s_cmp_lg_u32 s66, 0
    s_cbranch_scc1 L_21
    s_atomic_add s86, s[60:61], s64
L_21:
    ds_read_b64_tr_b16 a[66:67], v252 offset:576
    ds_read_b64_tr_b16 a[68:69], v252 offset:2688
    ds_read_b64_tr_b16 a[70:71], v252 offset:2752
    s_waitcnt lgkmcnt(15)
    v_mfma_f32_16x16x32_bf16 v[172:175], a[40:43], a[24:27], v[172:175]
    v_mfma_f32_16x16x32_bf16 v[172:175], a[44:47], a[28:31], v[172:175]
    v_mfma_f32_16x16x32_bf16 v[172:175], a[48:51], a[32:35], v[172:175]
    v_mfma_f32_16x16x32_bf16 v[172:175], a[52:55], a[36:39], v[172:175]
    ds_read_u8 v196, v1
    s_waitcnt lgkmcnt(1)
    v_mfma_f32_16x16x32_bf16 v[176:179], a[56:59], a[24:27], 0
    v_mfma_f32_16x16x32_bf16 v[176:179], a[60:63], a[28:31], v[176:179]
    v_mfma_f32_16x16x32_bf16 v[176:179], a[64:67], a[32:35], v[176:179]
    v_mfma_f32_16x16x32_bf16 v[176:179], a[68:71], a[36:39], v[176:179]
    s_waitcnt lgkmcnt(15)
    v_mfma_f32_16x16x32_bf16 v[180:183], a[72:75], a[24:27], 0
    v_mfma_f32_16x16x32_bf16 v[180:183], a[76:79], a[28:31], v[180:183]
    v_mfma_f32_16x16x32_bf16 v[180:183], a[80:83], a[32:35], v[180:183]
    v_mfma_f32_16x16x32_bf16 v[180:183], a[84:87], a[36:39], v[180:183]
    ds_write2_b32 v255, v172, v173 offset0:0 offset1:1
    ds_write2_b32 v255, v174, v175 offset0:2 offset1:3
    s_nop 0
    ds_write2_b32 v193, v176, v177 offset0:0 offset1:1
    ds_write2_b32 v194, v178, v179 offset0:0 offset1:1
    s_nop 2
    ds_write2_b32 v195, v180, v181 offset0:0 offset1:16
    ds_write2_b32 v195, v182, v183 offset0:33 offset1:49
    s_waitcnt vmcnt(18)
    ds_read_b64_tr_b16 a[176:177], v211 offset:0
    ds_read_b64_tr_b16 a[178:179], v211 offset:768
    ds_read_b64_tr_b16 a[180:181], v211 offset:32
    ds_read_b64_tr_b16 a[182:183], v211 offset:800
    ds_read_b64_tr_b16 a[184:185], v211 offset:64
    ds_read_b64_tr_b16 a[186:187], v211 offset:832
    ds_read_b64_tr_b16 a[188:189], v211 offset:96
    ds_read_b64_tr_b16 a[190:191], v211 offset:864
    ds_read_b64_tr_b16 a[192:193], v211 offset:128
    ds_read_b64_tr_b16 a[194:195], v211 offset:896
    ds_read_b64_tr_b16 a[196:197], v211 offset:160
    ds_read_b64_tr_b16 a[198:199], v211 offset:928
    ds_read_u8 v196, v1
    s_waitcnt lgkmcnt(1)
    v_mfma_f32_32x32x16_bf16 v[16:31], a[96:99], a[176:179], v[16:31]
    s_mov_b32 m0, s77
    s_nop 0
    buffer_load_dwordx4 v204, s[40:43], s75 offen offset:0 lds
    v_mfma_f32_32x32x16_bf16 v[32:47], a[96:99], a[180:183], v[32:47]
    buffer_load_dwordx4 v205, s[40:43], s75 offen offset:1024 lds
    buffer_load_dwordx4 v206, s[40:43], s75 offen offset:2048 lds
    v_mfma_f32_32x32x16_bf16 v[48:63], a[96:99], a[184:187], v[48:63]
    s_add_u32 m0, m0, 12320
    s_nop 0
    buffer_load_dwordx4 v204, s[44:47], s75 offen offset:0 lds
    v_mfma_f32_32x32x16_bf16 v[64:79], a[96:99], a[188:191], v[64:79]
    buffer_load_dwordx4 v205, s[44:47], s75 offen offset:1024 lds
    buffer_load_dwordx4 v206, s[44:47], s75 offen offset:2048 lds
    v_mfma_f32_32x32x16_bf16 v[80:95], a[96:99], a[192:195], v[80:95]
    s_lshr_b32 s89, s89, 4
    s_and_b32 s73, s89, 7
    v_mfma_f32_32x32x16_bf16 v[96:111], a[96:99], a[196:199], v[96:111]
    s_lshl_b32 s74, s73, 7
    s_mul_i32 s75, s73, 176128
    ds_read_u8 v196, v1
    s_waitcnt lgkmcnt(1)
    s_barrier
    ds_read2st64_b32 v[112:113], v213 offset0:0 offset1:17
    ds_read2st64_b32 v[114:115], v214 offset0:0 offset1:17
    ds_read2st64_b32 v[116:117], v215 offset0:0 offset1:17
    ds_read2st64_b32 v[118:119], v216 offset0:0 offset1:17
    ds_read2st64_b32 v[120:121], v217 offset0:0 offset1:17
    ds_read2st64_b32 v[122:123], v218 offset0:0 offset1:17
    ds_read2st64_b32 v[124:125], v219 offset0:0 offset1:17
    ds_read2st64_b32 v[126:127], v220 offset0:0 offset1:17
    ds_read2st64_b32 v[128:129], v221 offset0:0 offset1:17
    ds_read2st64_b32 v[130:131], v222 offset0:0 offset1:17
    ds_read2st64_b32 v[132:133], v223 offset0:0 offset1:17
    s_waitcnt vmcnt(12)
    ds_read_b64_tr_b16 a[176:177], v207 offset:0
    ds_read_b64_tr_b16 a[178:179], v207 offset:768
    ds_read_b64_tr_b16 a[180:181], v207 offset:32
    ds_read_b64_tr_b16 a[182:183], v207 offset:800
    ds_read_b64_tr_b16 a[184:185], v207 offset:64
    ds_read_b64_tr_b16 a[186:187], v207 offset:832
    ds_read_b64_tr_b16 a[188:189], v207 offset:96
    ds_read_b64_tr_b16 a[190:191], v207 offset:864
    ds_read_b64_tr_b16 a[192:193], v207 offset:128
    ds_read_b64_tr_b16 a[194:195], v207 offset:896
    ds_read_b64_tr_b16 a[196:197], v207 offset:160
    ds_read_b64_tr_b16 a[198:199], v207 offset:928
    ds_read_u8 v196, v1
    s_waitcnt lgkmcnt(1)
    v_mfma_f32_32x32x16_bf16 v[16:31], a[96:99], a[176:179], v[16:31]
    s_add_u32 m0, s77, 41216
    s_nop 0
    buffer_load_dwordx4 v204, s[40:43], s75 offen offset:0 lds
    v_mfma_f32_32x32x16_bf16 v[32:47], a[96:99], a[180:183], v[32:47]
    buffer_load_dwordx4 v205, s[40:43], s75 offen offset:1024 lds
    buffer_load_dwordx4 v206, s[40:43], s75 offen offset:2048 lds
    v_mfma_f32_32x32x16_bf16 v[48:63], a[96:99], a[184:187], v[48:63]
    s_add_u32 m0, m0, 12320
    s_nop 0
    buffer_load_dwordx4 v204, s[44:47], s75 offen offset:0 lds
    v_mfma_f32_32x32x16_bf16 v[64:79], a[96:99], a[188:191], v[64:79]
    buffer_load_dwordx4 v205, s[44:47], s75 offen offset:1024 lds
    buffer_load_dwordx4 v206, s[44:47], s75 offen offset:2048 lds
    v_mfma_f32_32x32x16_bf16 v[80:95], a[96:99], a[192:195], v[80:95]
    v_mfma_f32_32x32x16_bf16 v[96:111], a[96:99], a[196:199], v[96:111]
    ds_read2st64_b32 v[136:137], v213 offset0:34 offset1:51
    ds_read2st64_b32 v[138:139], v214 offset0:34 offset1:51
    ds_read2st64_b32 v[140:141], v215 offset0:34 offset1:51
    s_waitcnt lgkmcnt(15)
    v_add_f32 v112, v112, v113
    v_add_f32 v114, v114, v115
    ds_read2st64_b32 v[142:143], v216 offset0:34 offset1:51
    v_add_f32 v116, v116, v117
    v_add_f32 v118, v118, v119
    ds_read2st64_b32 v[144:145], v217 offset0:34 offset1:51
    s_waitcnt lgkmcnt(15)
    v_add_f32 v120, v120, v121
    v_add_f32 v122, v122, v123
    ds_read2st64_b32 v[146:147], v218 offset0:34 offset1:51
    v_add_f32 v124, v124, v125
    v_add_f32 v126, v126, v127
    ds_read2st64_b32 v[148:149], v219 offset0:34 offset1:51
    s_waitcnt lgkmcnt(15)
    v_add_f32 v128, v128, v129
    v_add_f32 v130, v130, v131
    ds_read2st64_b32 v[150:151], v220 offset0:34 offset1:51
    v_add_f32 v132, v132, v133
    s_waitcnt vmcnt(12)
    ds_read_b64_tr_b16 a[176:177], v208 offset:0
    ds_read_b64_tr_b16 a[178:179], v208 offset:768
    ds_read_b64_tr_b16 a[180:181], v208 offset:32
    ds_read_b64_tr_b16 a[182:183], v208 offset:800
    ds_read_b64_tr_b16 a[184:185], v208 offset:64
    ds_read_b64_tr_b16 a[186:187], v208 offset:832
    ds_read_b64_tr_b16 a[188:189], v208 offset:96
    ds_read_b64_tr_b16 a[190:191], v208 offset:864
    ds_read_b64_tr_b16 a[192:193], v208 offset:128
    ds_read_b64_tr_b16 a[194:195], v208 offset:896
    ds_read_b64_tr_b16 a[196:197], v208 offset:160
    ds_read_b64_tr_b16 a[198:199], v208 offset:928
    ds_read_u8 v196, v1
    s_waitcnt lgkmcnt(1)
    v_mfma_f32_32x32x16_bf16 v[16:31], a[96:99], a[176:179], v[16:31]
    v_mfma_f32_32x32x16_bf16 v[32:47], a[96:99], a[180:183], v[32:47]
    v_mfma_f32_32x32x16_bf16 v[48:63], a[96:99], a[184:187], v[48:63]
    v_mfma_f32_32x32x16_bf16 v[64:79], a[96:99], a[188:191], v[64:79]
    v_mfma_f32_32x32x16_bf16 v[80:95], a[96:99], a[192:195], v[80:95]
    v_mfma_f32_32x32x16_bf16 v[96:111], a[96:99], a[196:199], v[96:111]
    v_cvt_pk_bf16_f32 v160, v118, v120
    ds_read2st64_b32 v[152:153], v221 offset0:34 offset1:51
    v_cvt_pk_bf16_f32 v161, v122, v124
    v_cvt_pk_bf16_f32 v162, v126, v128
    ds_read2st64_b32 v[154:155], v222 offset0:34 offset1:51
    v_cvt_pk_bf16_f32 v163, v130, v132
    v_cvt_pk_bf16_f32 v164, v116, v118
    ds_read2st64_b32 v[156:157], v223 offset0:34 offset1:51
    v_cvt_pk_bf16_f32 v165, v120, v122
    v_cvt_pk_bf16_f32 v166, v124, v126
    v_cvt_pk_bf16_f32 v167, v128, v130
    v_cvt_pk_bf16_f32 v168, v114, v116
    v_cvt_pk_bf16_f32 v169, v118, v120
    v_cvt_pk_bf16_f32 v170, v122, v124
    v_cvt_pk_bf16_f32 v171, v126, v128
    v_cvt_pk_bf16_f32 v172, v112, v114
    v_cvt_pk_bf16_f32 v173, v116, v118
    v_cvt_pk_bf16_f32 v174, v120, v122
    v_cvt_pk_bf16_f32 v175, v124, v126
    s_waitcnt lgkmcnt(15)
    v_add_f32 v136, v136, v137
    v_add_f32 v138, v138, v139
    v_add_f32 v140, v140, v141
    v_add_f32 v142, v142, v143
    s_waitcnt lgkmcnt(15)
    v_add_f32 v144, v144, v145
    v_add_f32 v146, v146, v147
    v_add_f32 v148, v148, v149
    v_add_f32 v150, v150, v151
    ds_read_u8 v196, v1
    s_waitcnt lgkmcnt(1)
    v_add_f32 v152, v152, v153
    s_waitcnt vmcnt(6)
    ds_read_b64_tr_b16 a[176:177], v211 offset:0
    ds_read_b64_tr_b16 a[178:179], v211 offset:768
    ds_read_b64_tr_b16 a[180:181], v211 offset:32
    ds_read_b64_tr_b16 a[182:183], v211 offset:800
    ds_read_b64_tr_b16 a[184:185], v211 offset:64
    ds_read_b64_tr_b16 a[186:187], v211 offset:832
    ds_read_b64_tr_b16 a[188:189], v211 offset:96
    ds_read_b64_tr_b16 a[190:191], v211 offset:864
    ds_read_b64_tr_b16 a[192:193], v211 offset:128
    ds_read_b64_tr_b16 a[194:195], v211 offset:896
    ds_read_b64_tr_b16 a[196:197], v211 offset:160
    ds_read_b64_tr_b16 a[198:199], v211 offset:928
    ds_read_u8 v196, v1
    s_waitcnt lgkmcnt(1)
    v_mfma_f32_32x32x16_bf16 v[16:31], a[96:99], a[176:179], v[16:31]
    v_mfma_f32_32x32x16_bf16 v[32:47], a[96:99], a[180:183], v[32:47]
    v_mfma_f32_32x32x16_bf16 v[48:63], a[96:99], a[184:187], v[48:63]
    v_mfma_f32_32x32x16_bf16 v[64:79], a[96:99], a[188:191], v[64:79]
    v_mfma_f32_32x32x16_bf16 v[80:95], a[96:99], a[192:195], v[80:95]
    v_mfma_f32_32x32x16_bf16 v[96:111], a[96:99], a[196:199], v[96:111]
    v_add_f32 v154, v154, v155
    v_add_f32 v156, v156, v157
    v_cvt_pk_bf16_f32 v176, v142, v144
    v_cvt_pk_bf16_f32 v177, v146, v148
    v_cvt_pk_bf16_f32 v178, v150, v152
    v_cvt_pk_bf16_f32 v179, v154, v156
    v_cvt_pk_bf16_f32 v180, v140, v142
    v_cvt_pk_bf16_f32 v181, v144, v146
    v_cvt_pk_bf16_f32 v182, v148, v150
    v_cvt_pk_bf16_f32 v183, v152, v154
    v_cvt_pk_bf16_f32 v184, v138, v140
    v_cvt_pk_bf16_f32 v185, v142, v144
    v_cvt_pk_bf16_f32 v186, v146, v148
    v_cvt_pk_bf16_f32 v187, v150, v152
    v_cvt_pk_bf16_f32 v188, v136, v138
    v_cvt_pk_bf16_f32 v189, v140, v142
    v_cvt_pk_bf16_f32 v190, v144, v146
    v_cvt_pk_bf16_f32 v191, v148, v150
    ds_read_u8 v196, v1
    s_waitcnt lgkmcnt(1)
    s_barrier
    ds_write_b128 v212, v[160:163] offset:0
    ds_write_b128 v212, v[164:167] offset:4160
    s_waitcnt vmcnt(0)
    ds_read_b64_tr_b16 a[176:177], v207 offset:0
    ds_read_b64_tr_b16 a[178:179], v207 offset:768
    ds_read_b64_tr_b16 a[180:181], v207 offset:32
    ds_read_b64_tr_b16 a[182:183], v207 offset:800
    ds_read_b64_tr_b16 a[184:185], v207 offset:64
    ds_read_b64_tr_b16 a[186:187], v207 offset:832
    ds_read_b64_tr_b16 a[188:189], v207 offset:96
    ds_read_b64_tr_b16 a[190:191], v207 offset:864
    ds_read_b64_tr_b16 a[192:193], v207 offset:128
    ds_read_b64_tr_b16 a[194:195], v207 offset:896
    ds_read_b64_tr_b16 a[196:197], v207 offset:160
    ds_read_b64_tr_b16 a[198:199], v207 offset:928
    ds_read_u8 v196, v1
    s_waitcnt lgkmcnt(1)
    v_mfma_f32_32x32x16_bf16 v[16:31], a[96:99], a[176:179], v[16:31]
    v_mfma_f32_32x32x16_bf16 v[32:47], a[96:99], a[180:183], v[32:47]
    v_mfma_f32_32x32x16_bf16 v[48:63], a[96:99], a[184:187], v[48:63]
    v_mfma_f32_32x32x16_bf16 v[64:79], a[96:99], a[188:191], v[64:79]
    v_mfma_f32_32x32x16_bf16 v[80:95], a[96:99], a[192:195], v[80:95]
    v_mfma_f32_32x32x16_bf16 v[96:111], a[96:99], a[196:199], v[96:111]
    s_mul_i32 s81, s66, 768
    s_add_u32 s81, s81, 156928
    s_nop 4
    v_lshl_add_u32 v17, v5, 2, s81
    v_min_u32 v18, 191, v0
    v_lshlrev_b32 v18, 2, v18
    v_add_u32 v18, 156928, v18
    s_nop 1
    ds_write_b32 v17, v16 offset:0
    ds_write_b32 v17, v32 offset:128
    ds_write_b32 v17, v48 offset:256
    ds_write_b32 v17, v64 offset:384
    ds_write_b32 v17, v80 offset:512
    ds_write_b32 v17, v96 offset:640
    s_waitcnt lgkmcnt(0)
    s_barrier
    ds_read_b32 v20, v18 offset:0
    ds_read_b32 v21, v18 offset:768
    ds_read_b32 v22, v18 offset:1536
    ds_read_b32 v23, v18 offset:2304
    s_waitcnt lgkmcnt(0)
    v_add_f32 v20, v20, v21
    v_add_f32 v22, v22, v23
    v_add_f32 v20, v20, v22
    v_cvt_pk_bf16_f32 v21, v20, v20
    v_and_b32 v21, s85, v21
    v_sub_f32 v22, v20, v21
    v_cvt_pk_bf16_f32 v21, v21, v22
    buffer_store_dword v21, v241, s[52:55], 0 offen sc1
    ds_write_b128 v212, v[168:171] offset:8320
    ds_write_b128 v212, v[172:175] offset:12480
    ds_write_b128 v212, v[176:179] offset:16640
    ds_write_b128 v212, v[180:183] offset:20800
    ds_write_b128 v212, v[184:187] offset:24960
    ds_write_b128 v212, v[188:191] offset:29120
    ds_write_b128 v254, a[164:167]
    v_lshlrev_b32 v9, 2, v8
    v_xor_b32 v9, v9, v1
    v_and_b32 v9, 7, v9
    v_lshlrev_b32 v9, 4, v9
    v_lshrrev_b32 v192, 3, v1
    v_lshl_add_u32 v9, v192, 10, v9
    s_lshl_b32 s28, s33, 7
    v_add_u32 v226, s28, v9
    v_add_u32 v227, 7168, v226
    v_lshl_add_u32 v9, v6, 2, v3
    v_lshlrev_b32 v9, 7, v9
    v_lshrrev_b32 v192, 1, v3
    v_xor_b32 v192, s27, v192
    v_lshl_add_u32 v9, v192, 6, v9
    v_lshl_add_u32 v9, v8, 5, v9
    v_lshl_add_u32 v9, v4, 3, v9
    s_mul_i32 s87, s66, 10240
    s_mul_i32 s88, s66, 8192
    s_add_u32 s88, s88, 82432
    v_add_u32 v228, s87, v9
    v_xor_b32 v229, 64, v228
    v_add_u32 v230, s88, v9
    v_xor_b32 v231, 64, v230
    s_mul_i32 s28, s66, 22
    s_cmp_eq_u32 s66, 3
    s_cselect_b32 s28, 65, s28
    s_sub_u32 s29, 22, s27
    s_and_b32 s80, s65, 7
    s_mul_i32 s80, s80, 0
    s_lshr_b32 s79, s65, 3
    s_mul_i32 s79, s79, 5
    s_add_u32 s80, s80, s79
    v_add_u32 v9, s80, v1
    v_subrev_u32 v192, s29, v9
    v_min_u32 v9, v9, v192
    v_subrev_u32 v192, s29, v9
    v_min_u32 v9, v9, v192
    v_subrev_u32 v192, s29, v9
    v_min_u32 v9, v9, v192
    v_add_u32 v9, s28, v9
    v_lshlrev_b32 v192, 14, v9
    s_nop 0
    v_readlane_b32 s4, v192, 0
    v_readlane_b32 s5, v192, 1
    v_readlane_b32 s6, v192, 2
    v_readlane_b32 s7, v192, 3
    v_readlane_b32 s8, v192, 4
    v_readlane_b32 s9, v192, 5
    v_readlane_b32 s10, v192, 6
    v_readlane_b32 s11, v192, 7
    v_readlane_b32 s12, v192, 8
    v_readlane_b32 s13, v192, 9
    v_readlane_b32 s14, v192, 10
    v_readlane_b32 s15, v192, 11
    v_readlane_b32 s16, v192, 12
    v_readlane_b32 s17, v192, 13
    v_readlane_b32 s18, v192, 14
    v_readlane_b32 s19, v192, 15
    v_readlane_b32 s20, v192, 16
    v_readlane_b32 s21, v192, 17
    v_readlane_b32 s22, v192, 18
    v_readlane_b32 s23, v192, 19
    v_readlane_b32 s24, v192, 20
    v_readlane_b32 s25, v192, 21
    s_mul_i32 s28, s27, 16640
    s_lshl_b32 s29, s26, 8
    s_sub_u32 s28, s28, s29
    s_add_u32 s28, s28, 123928
    v_mul_u32_u24 v9, 4160, v4
    v_lshl_add_u32 v9, v2, 4, v9
    v_lshlrev_b32 v192, 3, v3
    v_sub_u32 v9, v9, v192
    v_add_u32 v224, s28, v9
    s_mul_i32 s28, s27, 37888
    s_sub_u32 s28, s28, s29
    s_add_u32 s28, s28, 119296
    v_lshlrev_b32 v9, 4, v2
    v_lshl_add_u32 v9, v7, 5, v9
    v_add_u32 v225, s28, v9
    s_lshl_b32 s28, s32, 1
    s_add_u32 s28, s28, s26
    s_mul_i32 s29, s28, 88064
    s_add_u32 s29, s29, 4194304
    v_lshl_add_u32 v232, v1, 4, s29
    s_xor_b32 s29, s28, 1
    s_mul_i32 s29, s29, 88064
    s_add_u32 s29, s29, 4194304
    v_lshl_add_u32 v233, v1, 4, s29
    s_lshl_b32 s29, s28, 5
    v_add_u32 v9, s29, v5
    v_lshlrev_b32 v192, 3, v9
    v_add_u32 v243, 2097156, v192
    s_lshl_b32 s29, s33, 1
    s_add_u32 s29, s29, s27
    s_lshl_b32 s31, s29, 6
    v_lshlrev_b32 v9, 10, v9
    v_lshl_add_u32 v9, v6, 4, v9
    v_add_u32 v242, s31, v9
    s_lshl_b32 s31, s29, 17
    s_lshl_b32 s28, s28, 6
    s_add_u32 s28, s28, s31
    s_add_u32 s28, s28, 10485760
    v_lshrrev_b32 v9, 2, v1
    v_lshlrev_b32 v9, 12, v9
    v_lshl_add_u32 v9, v4, 4, v9
    v_add_u32 v244, s28, v9
    s_mov_b32 s31, 0x10000
    s_lshl_b32 s28, s66, 11
    s_add_u32 s28, s28, 123648
    v_lshl_add_u32 v245, v1, 4, s28
    v_lshl_add_u32 v9, v6, 2, v3
    v_lshlrev_b32 v9, 6, v9
    v_lshl_add_u32 v9, v8, 5, v9
    v_lshl_add_u32 v9, v4, 3, v9
    v_add_u32 v246, s28, v9
    s_lshl_b32 s29, s29, 11
    s_add_u32 s29, s29, 2195456
    v_lshl_add_u32 v250, v7, 7, s29
    s_lshr_b32 s28, s32, 1
    s_lshl_b32 s28, s28, 11
    s_add_u32 s28, s28, 2162688
    s_mul_i32 s29, s66, 7
    s_lshr_b32 s29, s29, 1
    s_add_u32 s79, s26, 3
    v_min_u32 v9, s79, v7
    v_add_u32 v9, s29, v9
    v_lshl_add_u32 v249, v9, 7, s28
    v_lshlrev_b32 v248, 4, v1
    buffer_load_dword v197, v253, s[60:63], 0 offen sc1
    s_waitcnt vmcnt(0)
    v_cmp_gt_u32 vcc, 64, v197
    s_cbranch_vccnz RT_23
OK_22:
    s_barrier
    buffer_load_dwordx4 a[156:159], v237, s[52:55], 0 offen sc1
    buffer_load_dwordx4 a[160:163], v237, s[52:55], s30 offen sc1
    s_mov_b32 m0, s88
    s_nop 0
    buffer_load_dwordx4 v226, s[48:51], s4 offen offset:0 lds
    buffer_load_dwordx4 v227, s[48:51], s4 offen offset:1024 lds
    s_add_u32 m0, s88, 2048
    s_nop 0
    buffer_load_dwordx4 v226, s[48:51], s5 offen offset:0 lds
    buffer_load_dwordx4 v227, s[48:51], s5 offen offset:1024 lds
    s_add_u32 m0, s88, 4096
    s_nop 0
    buffer_load_dwordx4 v226, s[48:51], s6 offen offset:0 lds
    buffer_load_dwordx4 v227, s[48:51], s6 offen offset:1024 lds
    ds_write_b128 v239, a[164:167]
    s_waitcnt vmcnt(6)
    ds_write_b128 v238, a[156:159] offset:0
    s_waitcnt vmcnt(6)
    ds_write_b128 v238, a[160:163] offset:2048
    v_mov_b32 v9, 0x80000000
    buffer_load_dword v10, v9, s[52:55], 0 offen
    buffer_load_dword v10, v9, s[52:55], 0 offen
    buffer_load_dword v10, v9, s[52:55], 0 offen
    buffer_load_dword v10, v9, s[52:55], 0 offen
    buffer_load_dword v10, v9, s[52:55], 0 offen
    buffer_load_dword v10, v9, s[52:55], 0 offen
    s_branch MRG_4
RT_7:
    s_movk_i32 s78, 4000
RL_8:
    s_sleep 16
    buffer_load_dword v197, v253, s[60:63], 0 offen sc1
    s_waitcnt vmcnt(0)
    v_cmp_gt_u32 vcc, 64, v197
    s_cbranch_vccz OK_6
    s_sub_u32 s78, s78, 1
    s_cmp_lg_u32 s78, 0
    s_cbranch_scc1 RL_8
    s_branch OK_6
RT_10:
    s_movk_i32 s78, 4000
RL_11:
    buffer_load_dword a144, v241, s[52:55], 0 offen sc1
    buffer_load_dword a146, v241, s[52:55], 0 offen offset:128 sc1
    buffer_load_dword a148, v241, s[52:55], 0 offen offset:256 sc1
    s_waitcnt vmcnt(0)
    v_accvgpr_read_b32 v9, a144
    v_accvgpr_read_b32 v10, a146
    v_accvgpr_read_b32 v11, a148
    v_max3_u32 v9, v9, v10, v11
    v_cmp_eq_u32 vcc, -1, v9
    s_cbranch_vccz OK_9
    s_sub_u32 s78, s78, 1
    s_cmp_lg_u32 s78, 0
    s_cbranch_scc1 RL_11
    s_branch OK_9
RT_13:
    s_movk_i32 s78, 4000
RL_14:
    s_sleep 8
    buffer_load_dword v100, v249, s[52:55], 0 offen sc1
    s_waitcnt vmcnt(0)
    v_cmp_ne_u32 vcc, 4, v100
    s_cbranch_vccz OK_12
    s_sub_u32 s78, s78, 1
    s_cmp_lg_u32 s78, 0
    s_cbranch_scc1 RL_14
    s_branch OK_12
RT_19:
    s_movk_i32 s78, 4000
RL_20:
    buffer_load_dwordx4 v[112:115], v244, s[52:55], 0 offen sc1
    buffer_load_dwordx4 v[116:119], v244, s[52:55], s31 offen sc1
    s_waitcnt vmcnt(0)
    v_max3_u32 v101, v112, v113, v114
    v_max3_u32 v102, v115, v116, v117
    v_max3_u32 v101, v101, v118, v119
    v_max_u32 v101, v101, v102
    v_cmp_eq_u32 vcc, -1, v101
    s_cbranch_vccz OK_18
    s_sub_u32 s78, s78, 1
    s_cmp_lg_u32 s78, 0
    s_cbranch_scc1 RL_20
    s_branch OK_18
RT_23:
    s_movk_i32 s78, 4000
RL_24:
    s_sleep 16
    buffer_load_dword v197, v253, s[60:63], 0 offen sc1
    s_waitcnt vmcnt(0)
    v_cmp_gt_u32 vcc, 64, v197
    s_cbranch_vccz OK_22
    s_sub_u32 s78, s78, 1
    s_cmp_lg_u32 s78, 0
    s_cbranch_scc1 RL_24
    s_branch OK_22
END_1:
    s_endpgm
.section .rodata,"a"
.p2align 6
.amdhsa_kernel parallel_sum__ssm_conv_s4__glu_gated_bilinear__prompt_kernel
  .amdhsa_next_free_vgpr 512
  .amdhsa_next_free_sgpr 102
  .amdhsa_accum_offset 256
  .amdhsa_group_segment_fixed_size 0
  .amdhsa_kernarg_size 128
  .amdhsa_user_sgpr_count 2
  .amdhsa_user_sgpr_kernarg_segment_ptr 1
  .amdhsa_system_sgpr_workgroup_id_x 1
.end_amdhsa_kernel
```
